```python
import torch

def _softmax(x, axis=-1):
    return torch.softmax(x, dim=axis)
def _gelu(x):
    return torch.nn.functional.gelu(x, approximate="tanh")
def _silu(x):
    return torch.nn.functional.silu(x)
def _sigmoid(x):
    return torch.sigmoid(x)
def _layernorm(x, axis=-1, eps=1e-5):
    m = x.mean(dim=axis, keepdim=True)
    v = x.var(dim=axis, keepdim=True, unbiased=False)
    return (x - m) / torch.sqrt(v + eps)
def _scatter_add(tgt, idx, src, axis=0):
    return tgt.clone().index_add_(axis, idx, src)
def _segment_sum(src, seg, n):
    out = torch.zeros((n,) + src.shape[1:], dtype=src.dtype)
    return out.index_add_(0, seg, src)
def _pad(x, pw):
    flat = tuple(v for pair in reversed(pw) for v in pair)
    return torch.nn.functional.pad(x, flat)

kernel_name = 'gather_scatter__hybrid_graph_tf_nagphormer__graph'

def setup_inputs():

    _w = (lambda a: (lambda t: t.to(torch.bfloat16) if t.is_floating_point() else t)(torch.as_tensor(a)))
    N, deg, D = 10000, 16, 128
    E = N * deg
    src = (lambda lo, hi, *s: torch.randint(lo, hi, s))(0, N, E).to(torch.int64)
    dst = (lambda lo, hi, *s: torch.randint(lo, hi, s))(0, N, E).to(torch.int64)
    deg_cnt = torch.bincount(dst, minlength=N).to(float) + 1.0
    sc = 1.0 / D ** 0.5
    return {
        "x": _w((lambda *s: torch.randn(*s, dtype=torch.bfloat16) * 0.1)(N, D)),
        "src": _w(src),
        "dst": _w(dst),
        "deg_inv_sqrt": _w(1.0 / (lambda _x: torch.sqrt(torch.as_tensor(_x)))(deg_cnt)),
        "wq": _w((lambda *s: torch.randn(*s, dtype=torch.bfloat16) * 3.2)(D, D) * sc),
        "wk": _w((lambda *s: torch.randn(*s, dtype=torch.bfloat16) * 3.2)(D, D) * sc),
        "wv": _w((lambda *s: torch.randn(*s, dtype=torch.bfloat16) * 0.1)(D, D) * sc),
        "wo": _w((lambda *s: torch.randn(*s, dtype=torch.bfloat16) * 0.1)(D, D) * sc),
        "w_r": _w((lambda *s: torch.randn(*s, dtype=torch.bfloat16) * 0.1)(D)),
    }

def reference(x, src, dst, deg_inv_sqrt, wq, wk, wv, wo, w_r):
    N, D = x.shape[0], x.shape[1]
    K = 7
    h = x
    toks = [x]
    for _ in range(K):
        msg = h[src] * deg_inv_sqrt[src, None] * deg_inv_sqrt[dst, None]
        h = _segment_sum(msg, dst, N)
        toks.append(h)
    tok = torch.stack(toks, axis=1)
    t = _layernorm(tok, axis=-1)
    q   = torch.einsum('nkd,de->nke', t, wq)
    key = torch.einsum('nkd,de->nke', t, wk)
    v   = torch.einsum('nkd,de->nke', t, wv)
    scale = 1.0 / (D ** 0.5)
    attn = _softmax(torch.einsum('nkd,nld->nkl', q, key) * scale, axis=-1)
    o = torch.einsum('nkl,nld->nkd', attn, v)
    o = tok + torch.einsum('nkd,de->nke', o, wo)
    r = _layernorm(o, axis=-1)
    alpha = _softmax(torch.einsum('nkd,d->nk', r, w_r), axis=-1)
    return torch.einsum('nk,nkd->nd', alpha, o)
```

```asm
; @launch grid=(256,1,1) block=(512,1,1) lds=163840
.amdgcn_target "amdgcn-amd-amdhsa--gfx950"
.text
.globl gather_scatter__hybrid_graph_tf_nagphormer__graph_kernel
.p2align 8
.type gather_scatter__hybrid_graph_tf_nagphormer__graph_kernel,@function
gather_scatter__hybrid_graph_tf_nagphormer__graph_kernel:
    s_cmp_ge_u32 s2, 256
    s_cbranch_scc1 L_end
    s_load_dwordx8 s[32:39], s[0:1], 0
    s_load_dwordx4 s[92:95], s[0:1], 80
    s_load_dwordx8 s[60:67], s[0:1], 32
    s_load_dwordx4 s[68:71], s[0:1], 64
    v_readfirstlane_b32 s44, v0
    v_and_b32 v1, 63, v0
    s_and_b32 s45, s2, 7
    s_lshr_b32 s46, s2, 3
    s_lshr_b32 s44, s44, 6
    s_getpc_b64 s[96:97]
L_pc:
    s_lshl_b32 s98, s46, 3
    s_add_u32 s98, s98, s44
    s_lshl_b32 s98, s98, 7
    v_lshl_add_u32 v40, v1, 1, s98
    v_min_u32 v40, L_code_end-L_pc-4, v40
    v_and_b32 v40, -4, v40
    global_load_dword v3, v40, s[96:97]
    v_lshlrev_b32 v43, 3, v0
    s_mul_i32 s96, s2, 2560
    v_mov_b32 v64, 0xfffc3fff
    v_mov_b32 v65, v64
    v_mov_b32 v66, v64
    v_mov_b32 v67, v64
    v_lshlrev_b32 v70, 4, v0
    v_lshlrev_b32 v71, 2, v0
    v_lshlrev_b32 v72, 7, v1
    v_add_u32 v72, 12288, v72
    v_lshlrev_b32 v73, 2, v1
    s_waitcnt lgkmcnt(0)
    s_load_dword s78, s[94:95], 262016
    s_mov_b32 s12, s36
    s_mov_b32 s13, s37
    s_mov_b32 s14, 640000
    s_mov_b32 s15, 0x20000
    s_mov_b32 s8, s34
    s_mov_b32 s9, s35
    s_mov_b32 s10, 640000
    s_mov_b32 s11, 0x20000
    buffer_load_dwordx2 v[56:57], v43, s[12:15], s96 offen
    buffer_load_dwordx2 v[58:59], v43, s[8:11], s96 offen
    ds_write_b128 v70, v[64:67] offset:12288
    ds_write_b32 v73, v72 offset:10496
    s_mov_b32 s4, s94
    s_mov_b32 s5, s95
    s_mov_b32 s6, 268435456
    s_mov_b32 s7, 0x20000
    s_mov_b32 s16, s32
    s_mov_b32 s17, s33
    s_mov_b32 s18, 2560000
    s_mov_b32 s19, 0x20000
    s_mov_b32 s20, s38
    s_mov_b32 s21, s39
    s_mov_b32 s22, 20000
    s_mov_b32 s23, 0x20000
    s_mov_b32 s28, s70
    s_mov_b32 s29, s71
    s_mov_b32 s30, 2560000
    s_mov_b32 s31, 0x20000
    s_and_b32 s47, s46, 7
    s_lshr_b32 s48, s46, 3
    s_lshl_b32 s96, s45, 2
    s_add_u32 s48, s48, s96
    s_lshl_b32 s49, s44, 3
    s_add_u32 s49, s49, s47
    s_mov_b32 s57, 0
    v_lshrrev_b32 v41, 3, v1
    v_and_b32 v42, 7, v1
    v_cmp_eq_u32 s[74:75], 7, v42
    v_lshlrev_b32 v42, 4, v42
    v_lshl_add_u32 v75, v41, 15, v42
    s_lshl_b32 s72, s44, 18
    s_lshl_b32 s97, s2, 7
    s_add_u32 s72, s72, s97
    s_add_u32 s72, s72, 4194304
    v_and_b32 v40, 7, v1
    v_lshrrev_b32 v41, 3, v1
    v_lshlrev_b32 v42, 8, v40
    v_lshl_add_u32 v42, v41, 4, v42
    s_lshl_b32 s96, s2, 13
    s_lshr_b32 s97, s44, 1
    s_lshl_b32 s92, s97, 11
    s_and_b32 s94, s44, 1
    s_lshl_b32 s95, s94, 7
    s_add_u32 s92, s92, s95
    s_add_u32 s92, s92, s96
    s_mov_b32 s80, s92
    s_lshr_b32 s96, s96, 2
    s_add_u32 s96, s96, s95
    s_add_u32 s96, s96, 2097152
    s_mov_b32 s81, s96
    v_mov_b32 v112, v42
    v_mul_u32_u24 v41, 640, v41
    v_lshl_add_u32 v41, v40, 3, v41
    s_mul_i32 s94, s94, 5120
    v_add_u32 v109, s94, v41
    s_lshl_b32 s97, s97, 6
    v_add_u32 v108, s97, v109
    v_lshlrev_b32 v40, 4, v1
    v_and_b32 v40, 16, v40
    s_waitcnt lgkmcnt(0)
    s_barrier
    s_add_u32 s78, s78, 0x100
    s_lshr_b32 s79, s78, 4
    s_not_b32 s79, s79
    s_and_b32 s79, s79, 15
    s_and_b32 s78, s78, -16
    s_or_b32 s43, s78, s79
    s_not_b32 s59, s43
    v_mov_b32 v23, s43
    s_mov_b32 s79, 0x3c000
    v_lshrrev_b32 v40, v40, v23
    v_lshlrev_b32 v88, 14, v40
    v_and_b32 v88, s79, v88
    v_lshlrev_b32 v89, 10, v40
    v_and_b32 v89, s79, v89
    v_lshlrev_b32 v90, 6, v40
    v_and_b32 v90, s79, v90
    v_lshlrev_b32 v91, 2, v40
    v_and_b32 v91, s79, v91
    s_waitcnt vmcnt(0)
    s_and_b32 s82, s46, 3
    s_cbranch_scc0 L_nox2
    buffer_load_dwordx4 v[100:103], v112, s[16:19], s80 offen
    buffer_load_dwordx4 v[104:107], v112, s[16:19], s81 offen
    s_cmp_lg_u32 s82, 1
    s_cbranch_scc1 L_nox2
    s_sub_u32 s80, s80, 65536
    s_sub_u32 s81, s81, 16384
    buffer_load_dwordx4 v[116:119], v112, s[16:19], s80 offen
    buffer_load_dwordx4 v[120:123], v112, s[16:19], s81 offen
L_nox2:
    s_cmp_ge_u32 s44, 5
    s_cbranch_scc1 L_g1_skip
    s_cmp_ge_u32 s2, 250
    s_cbranch_scc1 L_g1_skip
    s_movk_i32 s96, 0xfc00
    v_mov_b32 v40, 4
    v_lshrrev_b32 v41, 5, v56
    v_lshl_or_b32 v58, v56, 18, v58
    v_and_b32 v42, -4, v41
    v_lshl_add_u32 v41, v41, 2, s96
    v_min_u32 v41, v41, v42
    ds_add_rtn_u32 v60, v41, v40 offset:10496
    v_lshrrev_b32 v41, 5, v57
    v_lshl_or_b32 v59, v57, 18, v59
    v_and_b32 v42, -4, v41
    v_lshl_add_u32 v41, v41, 2, s96
    v_min_u32 v41, v41, v42
    ds_add_rtn_u32 v61, v41, v40 offset:10496
    s_waitcnt lgkmcnt(1)
    ds_write_b32 v60, v58
    s_waitcnt lgkmcnt(1)
    ds_write_b32 v61, v59
    s_waitcnt lgkmcnt(0)
L_g1_skip:
    s_barrier
    ds_read_b32 v74, v73 offset:10496
    ds_read_b128 v[64:67], v70 offset:12288
    s_sub_u32 s41, s2, 8
    s_cmp_eq_u32 s41, 17
    s_cselect_b32 s41, 99, s41
    s_lshr_b32 s76, s46, 2
    s_lshl_b32 s76, s76, 3
    s_add_u32 s76, s76, s45
    s_waitcnt lgkmcnt(1)
    v_sub_u32 v74, v74, v72
    v_cmp_lt_u32 vcc, 0x7c, v74
    s_nop 0
    s_cmp_lg_u64 vcc, 0
    s_cselect_b32 s97, 1, 0
    s_sub_u32 s97, 0xfffc3fff, s97
    v_mov_b32 v74, s97
    s_waitcnt lgkmcnt(0)
    v_xor_b32 v64, v64, v88
    v_cndmask_b32 v67, v67, v74, s[74:75]
    v_xor_b32 v65, v65, v89
    v_xor_b32 v66, v66, v90
    v_xor_b32 v67, v67, v91
    buffer_store_dwordx4 v[64:67], v75, s[4:7], s72 offen sc1
    s_getreg_b32 s99, hwreg(HW_REG_XCC_ID, 0, 4)
    s_add_u32 s96, s99, 1
    v_mov_b32 v22, s96
    s_lshl_b32 s96, s2, 7
    s_add_u32 s96, s96, 524288
    v_lshl_add_u32 v45, v1, 15, s96
    s_cmp_eq_u32 s82, 0
    s_cbranch_scc1 L_builder
    s_lshl_b32 s96, s2, 8
    s_lshr_b32 s97, s96, 2
    s_add_u32 s97, s97, 65280
    s_mov_b32 s92, 81920
    s_lshl_b32 s94, s44, 6
    v_add_u32 v40, s94, v1
    v_add_u32 v40, 0, v40
    v_mul_u32_u24 v41, 3277, v40
    v_lshrrev_b32 v41, 16, v41
    v_mul_u32_u24 v42, 20, v41
    v_sub_u32 v42, v40, v42
    v_mov_b32 v40, s97
    v_mov_b32 v43, s96
    v_cmp_gt_u32 vcc, 16, v42
    v_mul_lo_u32 v41, v41, s92
    s_nop 0
    v_cndmask_b32 v40, v40, v43, vcc
    v_lshl_add_u32 v40, v42, 4, v40
    v_add_u32 v97, v41, v40
    v_lshrrev_b32 v40, 2, v40
    buffer_load_dword v110, v40, s[20:23], 0 offen
    v_mov_b32 v41, 512
    v_mov_b32 v43, 0x800
    v_cndmask_b32 v41, v41, v43, vcc
    v_sub_u32 v126, v97, v41
    v_lshrrev_b32 v41, 2, v41
    v_sub_u32 v40, v40, v41
    buffer_load_dword v124, v40, s[20:23], 0 offen
    v_add_u32 v40, s94, v1
    v_add_u32 v40, 512, v40
    v_mul_u32_u24 v41, 3277, v40
    v_lshrrev_b32 v41, 16, v41
    v_mul_u32_u24 v42, 20, v41
    v_sub_u32 v42, v40, v42
    v_mov_b32 v40, s97
    v_mov_b32 v43, s96
    v_cmp_gt_u32 vcc, 16, v42
    v_mul_lo_u32 v41, v41, s92
    s_nop 0
    v_cndmask_b32 v40, v40, v43, vcc
    v_lshl_add_u32 v40, v42, 4, v40
    v_add_u32 v98, v41, v40
    v_lshrrev_b32 v40, 2, v40
    buffer_load_dword v111, v40, s[20:23], 0 offen
    v_mov_b32 v41, 512
    v_mov_b32 v43, 0x800
    v_cndmask_b32 v41, v41, v43, vcc
    v_sub_u32 v127, v98, v41
    v_lshrrev_b32 v41, 2, v41
    v_sub_u32 v40, v40, v41
    buffer_load_dword v125, v40, s[20:23], 0 offen
    s_bitcmp1_b32 s44, 0
    s_cselect_b32 s72, s62, s60
    s_cselect_b32 s73, s63, s61
    s_cselect_b32 s74, s66, s64
    s_cselect_b32 s75, s67, s65
    s_bitcmp1_b32 s44, 1
    s_cselect_b32 s72, s74, s72
    s_cselect_b32 s73, s75, s73
    s_lshr_b32 s92, s46, 2
    s_sub_u32 s92, s46, s92
    s_sub_u32 s92, s92, 1
    s_lshl_b32 s92, s92, 1
    s_lshr_b32 s93, s44, 2
    s_add_u32 s92, s92, s93
    s_lshl_b32 s92, s92, 10
    v_lshl_add_u32 v41, v1, 4, s92
    v_min_u32 v41, 32764, v41
    global_load_dword v3, v41, s[72:73]
    v_lshrrev_b32 v41, 4, v1
    v_and_b32 v42, 15, v1
    v_lshl_add_u32 v41, v41, 3, v42
    v_mov_b32 v43, 0x2000000
    v_cmp_gt_u32 vcc, 8, v42
    s_nop 1
    v_cndmask_b32 v96, v43, v41, vcc
    s_mul_i32 s96, s48, 81920
    s_lshl_b32 s97, s49, 10
    s_add_u32 s97, s97, s96
    v_lshl_add_u32 v33, v1, 4, s97
    s_lshl_b32 s97, s49, 8
    s_add_u32 s97, s97, s96
    s_add_u32 s97, s97, 65536
    v_lshl_add_u32 v34, v96, 3, s97
    s_mov_b32 s53, 1048576
    s_mov_b32 s54, 8388608
    s_lshl_b32 s97, s44, 13
    s_add_u32 s100, s97, 81920
    s_add_u32 s97, s97, s96
    v_lshl_add_u32 v35, v1, 4, s97
    s_lshl_b32 s97, s44, 12
    s_add_u32 s101, s97, 147456
    s_add_u32 s97, s97, s96
    s_add_u32 s97, s97, 65536
    v_lshl_add_u32 v36, v1, 4, s97
    s_lshl_b32 s96, s48, 3
    s_add_u32 s96, s96, s44
    s_lshl_b32 s96, s96, 7
    v_lshl_add_u32 v37, v1, 3, s96
    s_lshl_b32 s97, s47, 3
    s_add_u32 s96, s96, s97
    v_mov_b32 v38, s96
    v_and_b32 v80, 15, v1
    v_lshrrev_b32 v81, 4, v1
    v_and_b32 v82, 3, v80
    v_lshrrev_b32 v80, 2, v80
    v_mov_b32 v83, 0x3f803f80
    v_cmp_eq_u32 vcc, v81, v82
    s_nop 1
    v_cndmask_b32 v83, 0, v83, vcc
    v_cmp_eq_u32 vcc, 0, v80
    s_nop 1
    v_cndmask_b32 v240, 0, v83, vcc
    v_cndmask_b32 v241, 0, v83, vcc
    v_cndmask_b32 v242, 0, v83, vcc
    v_cndmask_b32 v243, 0, v83, vcc
    v_cmp_eq_u32 vcc, 1, v80
    s_nop 1
    v_cndmask_b32 v244, 0, v83, vcc
    v_cndmask_b32 v245, 0, v83, vcc
    v_cndmask_b32 v246, 0, v83, vcc
    v_cndmask_b32 v247, 0, v83, vcc
    v_cmp_eq_u32 vcc, 2, v80
    s_nop 1
    v_cndmask_b32 v248, 0, v83, vcc
    v_cndmask_b32 v249, 0, v83, vcc
    v_cndmask_b32 v250, 0, v83, vcc
    v_cndmask_b32 v251, 0, v83, vcc
    v_cmp_eq_u32 vcc, 3, v80
    s_nop 1
    v_cndmask_b32 v252, 0, v83, vcc
    v_cndmask_b32 v253, 0, v83, vcc
    v_cndmask_b32 v254, 0, v83, vcc
    v_cndmask_b32 v255, 0, v83, vcc
    s_lshl_b32 s96, s44, 5
    v_add_u32 v41, s96, v1
    s_and_b32 s96, s2, 0xc7
    s_sub_u32 s96, s96, 256
    v_lshl_add_u32 v42, v1, 3, s96
    v_and_b32 v43, 24, v41
    v_cmp_eq_u32 vcc, 0, v43
    v_or_b32 v43, 8, v41
    s_nop 0
    v_cndmask_b32 v41, v41, v43, vcc
    v_cmp_gt_u32 vcc, 32, v1
    s_nop 1
    v_cndmask_b32 v41, v42, v41, vcc
    v_lshlrev_b32 v39, 7, v41
    s_lshl_b32 s96, s45, 15
    s_add_u32 s96, s96, 524288
    v_add_u32 v39, s96, v39
    v_lshlrev_b32 v82, 14, v88
    v_and_b32 v82, 0xc0000000, v82
    v_and_b32 v88, 0xc000, v88
    v_or_b32 v88, v88, v82
    v_lshlrev_b32 v82, 14, v89
    v_and_b32 v82, 0xc0000000, v82
    v_and_b32 v89, 0xc000, v89
    v_or_b32 v89, v89, v82
    v_lshlrev_b32 v82, 14, v90
    v_and_b32 v82, 0xc0000000, v82
    v_and_b32 v90, 0xc000, v90
    v_or_b32 v90, v90, v82
    v_lshlrev_b32 v82, 14, v91
    v_and_b32 v82, 0xc0000000, v82
    v_and_b32 v91, 0xc000, v91
    v_or_b32 v91, v91, v82
    s_waitcnt vmcnt(7)
    ds_write_b64 v108, v[100:101] offset:0
    ds_write_b64 v108, v[102:103] offset:320
    s_waitcnt vmcnt(6)
    ds_write_b64 v109, v[104:105] offset:256
    ds_write_b64 v109, v[106:107] offset:576
    s_cmp_lg_u32 s82, 1
    s_cbranch_scc1 L_nox3
    s_waitcnt vmcnt(6)
    ds_write_b64 v108, v[116:117] offset:40960
    ds_write_b64 v108, v[118:119] offset:41280
    ds_write_b64 v109, v[120:121] offset:41216
    ds_write_b64 v109, v[122:123] offset:41536
L_nox3:
    s_waitcnt lgkmcnt(0)
    s_barrier
    ds_read_b128 v[100:103], v70 offset:0
    ds_read_b128 v[104:107], v70 offset:8192
    s_waitcnt vmcnt(4)
    v_and_b32 v113, 0xffff0000, v110
    v_lshlrev_b32 v112, 16, v110
    s_waitcnt vmcnt(2)
    v_and_b32 v115, 0xffff0000, v111
    v_lshlrev_b32 v114, 16, v111
    s_waitcnt lgkmcnt(1)
    v_lshlrev_b32 v4, 16, v100
    v_and_b32 v5, 0xffff0000, v100
    v_lshlrev_b32 v6, 16, v101
    v_and_b32 v7, 0xffff0000, v101
    v_mul_f32 v4, v4, v112
    v_mul_f32 v5, v5, v112
    v_mul_f32 v6, v6, v112
    v_mul_f32 v7, v7, v112
    v_cvt_pk_bf16_f32 v16, v4, v5
    v_cvt_pk_bf16_f32 v17, v6, v7
    v_lshlrev_b32 v8, 16, v102
    v_and_b32 v9, 0xffff0000, v102
    v_lshlrev_b32 v10, 16, v103
    v_and_b32 v11, 0xffff0000, v103
    v_mul_f32 v8, v8, v113
    v_mul_f32 v9, v9, v113
    v_mul_f32 v10, v10, v113
    v_mul_f32 v11, v11, v113
    v_cvt_pk_bf16_f32 v18, v8, v9
    v_cvt_pk_bf16_f32 v19, v10, v11
    buffer_store_dwordx4 v[16:19], v97, s[4:7], s53 offen sc1
    s_cmp_ge_u32 s44, 2
    s_cbranch_scc1 L_g0ba
    s_waitcnt lgkmcnt(0)
    v_lshlrev_b32 v4, 16, v104
    v_and_b32 v5, 0xffff0000, v104
    v_lshlrev_b32 v6, 16, v105
    v_and_b32 v7, 0xffff0000, v105
    v_mul_f32 v4, v4, v114
    v_mul_f32 v5, v5, v114
    v_mul_f32 v6, v6, v114
    v_mul_f32 v7, v7, v114
    v_cvt_pk_bf16_f32 v24, v4, v5
    v_cvt_pk_bf16_f32 v25, v6, v7
    v_lshlrev_b32 v8, 16, v106
    v_and_b32 v9, 0xffff0000, v106
    v_lshlrev_b32 v10, 16, v107
    v_and_b32 v11, 0xffff0000, v107
    v_mul_f32 v8, v8, v115
    v_mul_f32 v9, v9, v115
    v_mul_f32 v10, v10, v115
    v_mul_f32 v11, v11, v115
    v_cvt_pk_bf16_f32 v26, v8, v9
    v_cvt_pk_bf16_f32 v27, v10, v11
    buffer_store_dwordx4 v[24:27], v98, s[4:7], s53 offen sc1
    s_nop 1
L_g0ba:
    s_waitcnt lgkmcnt(0)
    s_cmp_lg_u32 s82, 1
    s_cbranch_scc1 L_nox4
    ds_read_b128 v[100:103], v70 offset:40960
    ds_read_b128 v[104:107], v70 offset:49152
    v_and_b32 v113, 0xffff0000, v124
    v_lshlrev_b32 v112, 16, v124
    s_waitcnt vmcnt(3)
    v_and_b32 v115, 0xffff0000, v125
    v_lshlrev_b32 v114, 16, v125
    s_waitcnt lgkmcnt(1)
    v_lshlrev_b32 v4, 16, v100
    v_and_b32 v5, 0xffff0000, v100
    v_lshlrev_b32 v6, 16, v101
    v_and_b32 v7, 0xffff0000, v101
    v_mul_f32 v4, v4, v112
    v_mul_f32 v5, v5, v112
    v_mul_f32 v6, v6, v112
    v_mul_f32 v7, v7, v112
    v_cvt_pk_bf16_f32 v16, v4, v5
    v_cvt_pk_bf16_f32 v17, v6, v7
    v_lshlrev_b32 v8, 16, v102
    v_and_b32 v9, 0xffff0000, v102
    v_lshlrev_b32 v10, 16, v103
    v_and_b32 v11, 0xffff0000, v103
    v_mul_f32 v8, v8, v113
    v_mul_f32 v9, v9, v113
    v_mul_f32 v10, v10, v113
    v_mul_f32 v11, v11, v113
    v_cvt_pk_bf16_f32 v18, v8, v9
    v_cvt_pk_bf16_f32 v19, v10, v11
    buffer_store_dwordx4 v[16:19], v126, s[4:7], s53 offen sc1
    s_cmp_ge_u32 s44, 2
    s_cbranch_scc1 L_g0bb
    s_waitcnt lgkmcnt(0)
    v_lshlrev_b32 v4, 16, v104
    v_and_b32 v5, 0xffff0000, v104
    v_lshlrev_b32 v6, 16, v105
    v_and_b32 v7, 0xffff0000, v105
    v_mul_f32 v4, v4, v114
    v_mul_f32 v5, v5, v114
    v_mul_f32 v6, v6, v114
    v_mul_f32 v7, v7, v114
    v_cvt_pk_bf16_f32 v24, v4, v5
    v_cvt_pk_bf16_f32 v25, v6, v7
    v_lshlrev_b32 v8, 16, v106
    v_and_b32 v9, 0xffff0000, v106
    v_lshlrev_b32 v10, 16, v107
    v_and_b32 v11, 0xffff0000, v107
    v_mul_f32 v8, v8, v115
    v_mul_f32 v9, v9, v115
    v_mul_f32 v10, v10, v115
    v_mul_f32 v11, v11, v115
    v_cvt_pk_bf16_f32 v26, v8, v9
    v_cvt_pk_bf16_f32 v27, v10, v11
    buffer_store_dwordx4 v[24:27], v127, s[4:7], s53 offen sc1
    s_nop 1
L_g0bb:
    s_waitcnt lgkmcnt(0)
L_nox4:
    s_waitcnt vmcnt(0)
    s_barrier
    s_cmp_lg_u32 s44, 0
    s_cbranch_scc1 L_ng0a
    s_mov_b64 exec, 0xff
    buffer_store_dwordx2 v[22:23], v45, s[4:7], 0 offen sc1
    s_mov_b64 exec, -1
L_ng0a:
    s_branch L_fill0
L_builder:
    v_bfe_u32 v85, v1, 4, 2
    v_lshlrev_b32 v85, 5, v85
    v_lshlrev_b32 v84, 4, v1
    v_xor_b32 v84, v84, v85
    v_lshrrev_b32 v136, 1, v1
    v_lshlrev_b32 v136, 7, v136
    v_and_b32 v85, 1, v1
    v_lshl_add_u32 v136, v85, 4, v136
    v_bfe_u32 v85, v1, 2, 2
    v_lshl_add_u32 v136, v85, 5, v136
    s_lshl_b32 s79, s44, 12
    s_add_u32 s79, s79, 50176
    v_add_u32 v136, s79, v136
    v_xor_b32 v137, 32, v136
    v_xor_b32 v138, 64, v136
    v_xor_b32 v139, 0x60, v136
    s_mov_b32 s77, s76
    s_lshl_b32 s98, s76, 15
    s_lshl_b32 s97, s44, 12
    s_add_u32 s98, s98, s97
    s_add_u32 s98, s98, 4194304
    s_cmp_lg_u32 s44, 7
    s_cbranch_scc1 L_ng0b
    s_mov_b64 exec, 0xff
    buffer_store_dwordx2 v[22:23], v45, s[4:7], 0 offen sc1
    s_mov_b64 exec, -1
L_ng0b:
    v_mov_b32 v76, 0x27ff27ff
    v_mov_b32 v77, 0x27ff27ff
    v_mov_b32 v78, 0x27ff27ff
    v_mov_b32 v79, 0x27ff27ff
    ds_write_b128 v70, v[76:79] offset:20480
    ds_write_b128 v70, v[76:79] offset:27648
    v_and_b32 v76, 31, v0
    v_mul_u32_u24 v77, 43, v76
    v_lshrrev_b32 v77, 8, v77
    v_mul_u32_u24 v77, 6, v77
    v_sub_u32 v76, v76, v77
    ds_write_b32 v71, v76 offset:39424
    ds_write_b32 v71, v76 offset:40192
    v_and_b32 v76, 1, v0
    v_bfe_u32 v77, v0, 3, 2
    v_lshl_add_u32 v80, v76, 2, v77
    v_bfe_u32 v76, v0, 1, 2
    v_bfe_u32 v77, v0, 5, 2
    v_bfe_u32 v78, v0, 2, 1
    v_add_u32 v78, 8, v78
    v_and_b32 v79, 3, v0
    v_bfe_u32 v81, v0, 3, 2
    v_cmp_gt_u32 vcc, 0x80, v0
    s_nop 1
    v_cndmask_b32 v80, v78, v80, vcc
    v_cndmask_b32 v76, v79, v76, vcc
    v_cndmask_b32 v77, v81, v77, vcc
    v_lshrrev_b32 v79, 1, v76
    v_lshl_add_u32 v79, v80, 1, v79
    v_lshlrev_b32 v79, 7, v79
    v_add_u32 v79, 39424, v79
    v_lshl_add_u32 v76, v76, 4, v77
    v_lshlrev_b32 v76, 4, v76
    v_and_b32 v77, 1, v80
    v_lshl_add_u32 v76, v77, 3, v76
    v_lshrrev_b32 v77, 1, v80
    v_lshl_add_u32 v76, v77, 10, v76
    v_add_u32 v78, 20480, v76
    v_add_u32 v77, 41220, v71
    v_cmp_gt_u32 vcc, 0xa0, v0
    s_nop 1
    v_cndmask_b32 v79, v77, v79, vcc
    v_mov_b32 v76, 0
    v_mov_b32 v77, 43008
    v_lshlrev_b32 v80, 3, v0
    v_cmp_gt_u32 vcc, 0xe0, v0
    s_nop 0
    s_and_saveexec_b64 s[92:93], vcc
    ds_write_b64 v80, v[78:79] offset:35840
    ds_write_b32 v71, v76 offset:37632
    ds_write_b32 v71, v76 offset:38272
    ds_write_b64 v76, v[76:77] offset:39296
    s_mov_b64 exec, s[92:93]
    s_lshl_b32 s96, s2, 8
    s_lshr_b32 s97, s96, 2
    s_add_u32 s97, s97, 65280
    s_mov_b32 s92, 81920
    s_lshl_b32 s94, s44, 6
    v_add_u32 v40, s94, v1
    v_add_u32 v40, 0, v40
    v_mul_u32_u24 v41, 3277, v40
    v_lshrrev_b32 v41, 16, v41
    v_mul_u32_u24 v42, 20, v41
    v_sub_u32 v42, v40, v42
    v_mov_b32 v40, s97
    v_mov_b32 v43, s96
    v_cmp_gt_u32 vcc, 16, v42
    v_mul_lo_u32 v41, v41, s92
    s_nop 0
    v_cndmask_b32 v40, v40, v43, vcc
    v_lshl_add_u32 v40, v42, 4, v40
    v_add_u32 v97, v41, v40
    v_add_u32 v40, s94, v1
    v_add_u32 v40, 512, v40
    v_mul_u32_u24 v41, 3277, v40
    v_lshrrev_b32 v41, 16, v41
    v_mul_u32_u24 v42, 20, v41
    v_sub_u32 v42, v40, v42
    v_mov_b32 v40, s97
    v_mov_b32 v43, s96
    v_cmp_gt_u32 vcc, 16, v42
    v_mul_lo_u32 v41, v41, s92
    s_nop 0
    v_cndmask_b32 v40, v40, v43, vcc
    v_lshl_add_u32 v40, v42, 4, v40
    v_add_u32 v98, v41, v40
    v_lshrrev_b32 v41, 4, v1
    v_and_b32 v42, 15, v1
    v_lshl_add_u32 v41, v41, 3, v42
    v_mov_b32 v43, 0x2000000
    v_cmp_gt_u32 vcc, 8, v42
    s_nop 1
    v_cndmask_b32 v96, v43, v41, vcc
    s_mul_i32 s96, s48, 81920
    s_lshl_b32 s97, s49, 10
    s_add_u32 s97, s97, s96
    v_lshl_add_u32 v33, v1, 4, s97
    s_lshl_b32 s97, s49, 8
    s_add_u32 s97, s97, s96
    s_add_u32 s97, s97, 65536
    v_lshl_add_u32 v34, v96, 3, s97
    s_mov_b32 s53, 1048576
    s_mov_b32 s54, 8388608
    s_lshl_b32 s97, s44, 13
    s_add_u32 s100, s97, 81920
    s_add_u32 s97, s97, s96
    v_lshl_add_u32 v35, v1, 4, s97
    s_lshl_b32 s97, s44, 12
    s_add_u32 s101, s97, 147456
    s_add_u32 s97, s97, s96
    s_add_u32 s97, s97, 65536
    v_lshl_add_u32 v36, v1, 4, s97
    s_lshl_b32 s96, s48, 3
    s_add_u32 s96, s96, s44
    s_lshl_b32 s96, s96, 7
    v_lshl_add_u32 v37, v1, 3, s96
    s_lshl_b32 s97, s47, 3
    s_add_u32 s96, s96, s97
    v_mov_b32 v38, s96
    v_and_b32 v80, 15, v1
    v_lshrrev_b32 v81, 4, v1
    v_and_b32 v82, 3, v80
    v_lshrrev_b32 v80, 2, v80
    v_mov_b32 v83, 0x3f803f80
    v_cmp_eq_u32 vcc, v81, v82
    s_nop 1
    v_cndmask_b32 v83, 0, v83, vcc
    v_cmp_eq_u32 vcc, 0, v80
    s_nop 1
    v_cndmask_b32 v240, 0, v83, vcc
    v_cndmask_b32 v241, 0, v83, vcc
    v_cndmask_b32 v242, 0, v83, vcc
    v_cndmask_b32 v243, 0, v83, vcc
    v_cmp_eq_u32 vcc, 1, v80
    s_nop 1
    v_cndmask_b32 v244, 0, v83, vcc
    v_cndmask_b32 v245, 0, v83, vcc
    v_cndmask_b32 v246, 0, v83, vcc
    v_cndmask_b32 v247, 0, v83, vcc
    v_cmp_eq_u32 vcc, 2, v80
    s_nop 1
    v_cndmask_b32 v248, 0, v83, vcc
    v_cndmask_b32 v249, 0, v83, vcc
    v_cndmask_b32 v250, 0, v83, vcc
    v_cndmask_b32 v251, 0, v83, vcc
    v_cmp_eq_u32 vcc, 3, v80
    s_nop 1
    v_cndmask_b32 v252, 0, v83, vcc
    v_cndmask_b32 v253, 0, v83, vcc
    v_cndmask_b32 v254, 0, v83, vcc
    v_cndmask_b32 v255, 0, v83, vcc
    s_lshl_b32 s96, s44, 5
    v_add_u32 v41, s96, v1
    s_and_b32 s96, s2, 0xc7
    s_sub_u32 s96, s96, 256
    v_lshl_add_u32 v42, v1, 3, s96
    v_and_b32 v43, 24, v41
    v_cmp_eq_u32 vcc, 0, v43
    v_or_b32 v43, 8, v41
    s_nop 0
    v_cndmask_b32 v41, v41, v43, vcc
    v_cmp_gt_u32 vcc, 32, v1
    s_nop 1
    v_cndmask_b32 v41, v42, v41, vcc
    v_lshlrev_b32 v39, 7, v41
    s_lshl_b32 s96, s45, 15
    s_add_u32 s96, s96, 524288
    v_add_u32 v39, s96, v39
    v_mov_b32 v86, 1
    v_mov_b32 v87, 5
    v_mov_b32 v78, 0
    s_lshl_b32 s96, s77, 9
    s_lshl_b32 s97, s77, 7
    s_add_u32 s97, s97, 32256
    s_movk_i32 s92, 640
    s_movk_i32 s93, 5112
    v_lshlrev_b32 v70, 2, v1
    v_add_u32 v70, 640, v70
    v_mov_b32 v71, 4
    v_mov_b32 v72, 0
    s_waitcnt lgkmcnt(0)
    s_barrier
L_segagain:
    s_mov_b32 m0, s79
    s_nop 0
    buffer_load_dwordx4 v84, s[4:7], s98 offen offset:0 sc1 lds
    buffer_load_dwordx4 v84, s[4:7], s98 offen offset:1024 sc1 lds
    buffer_load_dwordx4 v84, s[4:7], s98 offen offset:2048 sc1 lds
    buffer_load_dwordx4 v84, s[4:7], s98 offen offset:3072 sc1 lds
    s_add_u32 s57, s57, 1
    s_cmp_gt_u32 s57, 4194304
    s_cbranch_scc1 L_end
    s_waitcnt vmcnt(0)
    ds_read_b128 v[46:49], v136
    ds_read_b128 v[50:53], v137
    ds_read_b128 v[54:57], v138
    ds_read_b128 v[58:61], v139
    s_waitcnt lgkmcnt(3)
    v_xor_b32 v46, v46, v88
    v_xor_b32 v47, v47, v89
    v_xor_b32 v48, v48, v90
    v_xor_b32 v49, v49, v91
    s_waitcnt lgkmcnt(2)
    v_xor_b32 v50, v50, v88
    v_xor_b32 v51, v51, v89
    v_xor_b32 v52, v52, v90
    v_xor_b32 v53, v53, v91
    s_waitcnt lgkmcnt(1)
    v_xor_b32 v54, v54, v88
    v_xor_b32 v55, v55, v89
    v_xor_b32 v56, v56, v90
    v_xor_b32 v57, v57, v91
    s_waitcnt lgkmcnt(0)
    v_xor_b32 v58, v58, v88
    v_xor_b32 v59, v59, v89
    v_xor_b32 v60, v60, v90
    v_xor_b32 v61, v61, v91
    v_or3_b32 v82, v46, v47, v48
    v_or3_b32 v82, v82, v49, v50
    v_or3_b32 v82, v82, v51, v52
    v_or3_b32 v82, v82, v53, v54
    v_or3_b32 v82, v82, v55, v56
    v_or3_b32 v82, v82, v57, v58
    v_or3_b32 v82, v82, v59, v60
    v_or_b32 v82, v82, v61
    v_and_b32 v82, 0x3c000, v82
    v_cmp_ne_u32 vcc, 0, v82
    s_cbranch_vccnz L_segagain
    v_lshrrev_b32 v82, 16, v46
    v_subrev_u32 v83, s96, v82
    v_subrev_u32 v82, s97, v82
    v_min3_u32 v62, v82, v83, v70
    v_lshlrev_b32 v82, 1, v62
    ds_read_b64 v[140:141], v82 offset:35840
    v_and_b32 v128, 31, v46
    v_lshrrev_b32 v82, 16, v47
    v_subrev_u32 v83, s96, v82
    v_subrev_u32 v82, s97, v82
    v_min3_u32 v63, v82, v83, v70
    v_lshlrev_b32 v82, 1, v63
    ds_read_b64 v[142:143], v82 offset:35840
    v_and_b32 v129, 31, v47
    v_lshrrev_b32 v82, 16, v48
    v_subrev_u32 v83, s96, v82
    v_subrev_u32 v82, s97, v82
    v_min3_u32 v64, v82, v83, v70
    v_lshlrev_b32 v82, 1, v64
    ds_read_b64 v[144:145], v82 offset:35840
    v_and_b32 v130, 31, v48
    v_lshrrev_b32 v82, 16, v49
    v_subrev_u32 v83, s96, v82
    v_subrev_u32 v82, s97, v82
    v_min3_u32 v65, v82, v83, v70
    v_lshlrev_b32 v82, 1, v65
    ds_read_b64 v[146:147], v82 offset:35840
    v_and_b32 v131, 31, v49
    v_lshrrev_b32 v82, 16, v50
    v_subrev_u32 v83, s96, v82
    v_subrev_u32 v82, s97, v82
    v_min3_u32 v66, v82, v83, v70
    v_lshlrev_b32 v82, 1, v66
    ds_read_b64 v[148:149], v82 offset:35840
    v_and_b32 v132, 31, v50
    v_lshrrev_b32 v82, 16, v51
    v_subrev_u32 v83, s96, v82
    v_subrev_u32 v82, s97, v82
    v_min3_u32 v67, v82, v83, v70
    v_lshlrev_b32 v82, 1, v67
    ds_read_b64 v[150:151], v82 offset:35840
    v_and_b32 v133, 31, v51
    v_lshrrev_b32 v82, 16, v52
    v_subrev_u32 v83, s96, v82
    v_subrev_u32 v82, s97, v82
    v_min3_u32 v68, v82, v83, v70
    v_lshlrev_b32 v82, 1, v68
    ds_read_b64 v[152:153], v82 offset:35840
    v_and_b32 v134, 31, v52
    v_lshrrev_b32 v82, 16, v53
    v_subrev_u32 v83, s96, v82
    v_subrev_u32 v82, s97, v82
    v_min3_u32 v69, v82, v83, v70
    v_lshlrev_b32 v82, 1, v69
    ds_read_b64 v[154:155], v82 offset:35840
    v_and_b32 v135, 31, v53
    s_waitcnt lgkmcnt(7)
    v_lshl_add_u32 v112, v128, 2, v141
    ds_inc_rtn_u32 v112, v112, v87
    s_waitcnt lgkmcnt(7)
    v_lshl_add_u32 v113, v129, 2, v143
    ds_inc_rtn_u32 v113, v113, v87
    s_waitcnt lgkmcnt(7)
    v_lshl_add_u32 v114, v130, 2, v145
    ds_inc_rtn_u32 v114, v114, v87
    s_waitcnt lgkmcnt(7)
    v_lshl_add_u32 v115, v131, 2, v147
    ds_inc_rtn_u32 v115, v115, v87
    s_waitcnt lgkmcnt(7)
    v_lshl_add_u32 v116, v132, 2, v149
    ds_inc_rtn_u32 v116, v116, v87
    s_waitcnt lgkmcnt(7)
    v_lshl_add_u32 v117, v133, 2, v151
    ds_inc_rtn_u32 v117, v117, v87
    s_waitcnt lgkmcnt(7)
    v_lshl_add_u32 v118, v134, 2, v153
    ds_inc_rtn_u32 v118, v118, v87
    s_waitcnt lgkmcnt(7)
    v_lshl_add_u32 v119, v135, 2, v155
    ds_inc_rtn_u32 v119, v119, v87
    s_mov_b32 s94, 0xfffc0000
    v_min3_u32 v82, v54, v55, v56
    v_min3_u32 v83, v57, v58, v59
    v_min3_u32 v82, v82, v60, v61
    v_min_u32 v82, v82, v83
    v_cmp_gt_u32 vcc, s94, v82
    s_cbranch_vccnz L_rare
L_rared:
    s_waitcnt lgkmcnt(7)
    v_mul_u32_u24 v128, 5, v112
    v_lshlrev_b32 v120, v128, v86
    ds_add_rtn_u32 v120, v62, v120 offset:37632
    v_lshrrev_b32 v82, 2, v112
    v_mad_u32_u24 v140, v82, s93, v140
    v_lshl_add_u32 v140, v112, 1, v140
    v_cmp_gt_u32 s[60:61], s92, v62
    s_waitcnt lgkmcnt(7)
    v_mul_u32_u24 v129, 5, v113
    v_lshlrev_b32 v121, v129, v86
    ds_add_rtn_u32 v121, v63, v121 offset:37632
    v_lshrrev_b32 v82, 2, v113
    v_mad_u32_u24 v142, v82, s93, v142
    v_lshl_add_u32 v142, v113, 1, v142
    v_cmp_gt_u32 s[62:63], s92, v63
    s_waitcnt lgkmcnt(7)
    v_mul_u32_u24 v130, 5, v114
    v_lshlrev_b32 v122, v130, v86
    ds_add_rtn_u32 v122, v64, v122 offset:37632
    v_lshrrev_b32 v82, 2, v114
    v_mad_u32_u24 v144, v82, s93, v144
    v_lshl_add_u32 v144, v114, 1, v144
    v_cmp_gt_u32 s[64:65], s92, v64
    s_waitcnt lgkmcnt(7)
    v_mul_u32_u24 v131, 5, v115
    v_lshlrev_b32 v123, v131, v86
    ds_add_rtn_u32 v123, v65, v123 offset:37632
    v_lshrrev_b32 v82, 2, v115
    v_mad_u32_u24 v146, v82, s93, v146
    v_lshl_add_u32 v146, v115, 1, v146
    v_cmp_gt_u32 s[66:67], s92, v65
    s_waitcnt lgkmcnt(7)
    v_mul_u32_u24 v132, 5, v116
    v_lshlrev_b32 v124, v132, v86
    ds_add_rtn_u32 v124, v66, v124 offset:37632
    v_lshrrev_b32 v82, 2, v116
    v_mad_u32_u24 v148, v82, s93, v148
    v_lshl_add_u32 v148, v116, 1, v148
    v_cmp_gt_u32 s[68:69], s92, v66
    s_waitcnt lgkmcnt(7)
    v_mul_u32_u24 v133, 5, v117
    v_lshlrev_b32 v125, v133, v86
    ds_add_rtn_u32 v125, v67, v125 offset:37632
    v_lshrrev_b32 v82, 2, v117
    v_mad_u32_u24 v150, v82, s93, v150
    v_lshl_add_u32 v150, v117, 1, v150
    v_cmp_gt_u32 s[70:71], s92, v67
    s_waitcnt lgkmcnt(7)
    v_mul_u32_u24 v134, 5, v118
    v_lshlrev_b32 v126, v134, v86
    ds_add_rtn_u32 v126, v68, v126 offset:37632
    v_lshrrev_b32 v82, 2, v118
    v_mad_u32_u24 v152, v82, s93, v152
    v_lshl_add_u32 v152, v118, 1, v152
    v_cmp_gt_u32 s[72:73], s92, v68
    s_waitcnt lgkmcnt(7)
    v_mul_u32_u24 v135, 5, v119
    v_lshlrev_b32 v127, v135, v86
    ds_add_rtn_u32 v127, v69, v127 offset:37632
    v_lshrrev_b32 v82, 2, v119
    v_mad_u32_u24 v154, v82, s93, v154
    v_lshl_add_u32 v154, v119, 1, v154
    v_cmp_gt_u32 s[74:75], s92, v69
    s_waitcnt lgkmcnt(7)
    v_bfe_u32 v83, v120, v128, 5
    s_mov_b64 exec, s[60:61]
    v_cmp_gt_u32 vcc, 4, v83
    v_lshl_add_u32 v82, v83, 6, v140
    v_max_u32 v78, v78, v83
    s_andn2_b64 s[60:61], s[60:61], vcc
    s_mov_b64 exec, vcc
    ds_write_b16 v82, v46
    s_mov_b64 exec, s[60:61]
    ds_add_rtn_u32 v112, v72, v71 offset:39300
    s_mov_b64 exec, -1
    s_waitcnt lgkmcnt(8)
    v_bfe_u32 v83, v121, v129, 5
    s_mov_b64 exec, s[62:63]
    v_cmp_gt_u32 vcc, 4, v83
    v_lshl_add_u32 v82, v83, 6, v142
    v_max_u32 v78, v78, v83
    s_andn2_b64 s[62:63], s[62:63], vcc
    s_mov_b64 exec, vcc
    ds_write_b16 v82, v47
    s_mov_b64 exec, s[62:63]
    ds_add_rtn_u32 v113, v72, v71 offset:39300
    s_mov_b64 exec, -1
    s_waitcnt lgkmcnt(9)
    v_bfe_u32 v83, v122, v130, 5
    s_mov_b64 exec, s[64:65]
    v_cmp_gt_u32 vcc, 4, v83
    v_lshl_add_u32 v82, v83, 6, v144
    v_max_u32 v78, v78, v83
    s_andn2_b64 s[64:65], s[64:65], vcc
    s_mov_b64 exec, vcc
    ds_write_b16 v82, v48
    s_mov_b64 exec, s[64:65]
    ds_add_rtn_u32 v114, v72, v71 offset:39300
    s_mov_b64 exec, -1
    s_waitcnt lgkmcnt(10)
    v_bfe_u32 v83, v123, v131, 5
    s_mov_b64 exec, s[66:67]
    v_cmp_gt_u32 vcc, 4, v83
    v_lshl_add_u32 v82, v83, 6, v146
    v_max_u32 v78, v78, v83
    s_andn2_b64 s[66:67], s[66:67], vcc
    s_mov_b64 exec, vcc
    ds_write_b16 v82, v49
    s_mov_b64 exec, s[66:67]
    ds_add_rtn_u32 v115, v72, v71 offset:39300
    s_mov_b64 exec, -1
    s_waitcnt lgkmcnt(11)
    v_bfe_u32 v83, v124, v132, 5
    s_mov_b64 exec, s[68:69]
    v_cmp_gt_u32 vcc, 4, v83
    v_lshl_add_u32 v82, v83, 6, v148
    v_max_u32 v78, v78, v83
    s_andn2_b64 s[68:69], s[68:69], vcc
    s_mov_b64 exec, vcc
    ds_write_b16 v82, v50
    s_mov_b64 exec, s[68:69]
    ds_add_rtn_u32 v116, v72, v71 offset:39300
    s_mov_b64 exec, -1
    s_waitcnt lgkmcnt(12)
    v_bfe_u32 v83, v125, v133, 5
    s_mov_b64 exec, s[70:71]
    v_cmp_gt_u32 vcc, 4, v83
    v_lshl_add_u32 v82, v83, 6, v150
    v_max_u32 v78, v78, v83
    s_andn2_b64 s[70:71], s[70:71], vcc
    s_mov_b64 exec, vcc
    ds_write_b16 v82, v51
    s_mov_b64 exec, s[70:71]
    ds_add_rtn_u32 v117, v72, v71 offset:39300
    s_mov_b64 exec, -1
    s_waitcnt lgkmcnt(13)
    v_bfe_u32 v83, v126, v134, 5
    s_mov_b64 exec, s[72:73]
    v_cmp_gt_u32 vcc, 4, v83
    v_lshl_add_u32 v82, v83, 6, v152
    v_max_u32 v78, v78, v83
    s_andn2_b64 s[72:73], s[72:73], vcc
    s_mov_b64 exec, vcc
    ds_write_b16 v82, v52
    s_mov_b64 exec, s[72:73]
    ds_add_rtn_u32 v118, v72, v71 offset:39300
    s_mov_b64 exec, -1
    s_waitcnt lgkmcnt(14)
    v_bfe_u32 v83, v127, v135, 5
    s_mov_b64 exec, s[74:75]
    v_cmp_gt_u32 vcc, 4, v83
    v_lshl_add_u32 v82, v83, 6, v154
    v_max_u32 v78, v78, v83
    s_andn2_b64 s[74:75], s[74:75], vcc
    s_mov_b64 exec, vcc
    ds_write_b16 v82, v53
    s_mov_b64 exec, s[74:75]
    ds_add_rtn_u32 v119, v72, v71 offset:39300
    s_mov_b64 exec, -1
    s_mov_b64 exec, s[60:61]
    s_waitcnt lgkmcnt(14)
    ds_write_b32 v112, v46
    s_mov_b64 exec, s[62:63]
    s_waitcnt lgkmcnt(13)
    ds_write_b32 v113, v47
    s_mov_b64 exec, s[64:65]
    s_waitcnt lgkmcnt(12)
    ds_write_b32 v114, v48
    s_mov_b64 exec, s[66:67]
    s_waitcnt lgkmcnt(11)
    ds_write_b32 v115, v49
    s_mov_b64 exec, s[68:69]
    s_waitcnt lgkmcnt(10)
    ds_write_b32 v116, v50
    s_mov_b64 exec, s[70:71]
    s_waitcnt lgkmcnt(9)
    ds_write_b32 v117, v51
    s_mov_b64 exec, s[72:73]
    s_waitcnt lgkmcnt(8)
    ds_write_b32 v118, v52
    s_mov_b64 exec, s[74:75]
    s_waitcnt lgkmcnt(7)
    ds_write_b32 v119, v53
    s_mov_b64 exec, -1
    v_mov_b32 v83, 0xfffc3ffe
    v_cmp_eq_u32 vcc, v83, v61
    v_cmp_eq_u32 s[60:61], 31, v78
    s_nop 0
    s_or_b64 vcc, vcc, s[60:61]
    s_cbranch_vccnz L_ov_468
L_ovr_469:
    v_lshlrev_b32 v82, 14, v88
    v_and_b32 v82, 0xc0000000, v82
    v_and_b32 v88, 0xc000, v88
    v_or_b32 v88, v88, v82
    v_lshlrev_b32 v82, 14, v89
    v_and_b32 v82, 0xc0000000, v82
    v_and_b32 v89, 0xc000, v89
    v_or_b32 v89, v89, v82
    v_lshlrev_b32 v82, 14, v90
    v_and_b32 v82, 0xc0000000, v82
    v_and_b32 v90, 0xc000, v90
    v_or_b32 v90, v90, v82
    v_lshlrev_b32 v82, 14, v91
    v_and_b32 v82, 0xc0000000, v82
    v_and_b32 v91, 0xc000, v91
    v_or_b32 v91, v91, v82
    s_mul_i32 s94, s44, 1920
    v_lshl_add_u32 v43, v1, 4, s94
    v_mov_b32 v41, 0
    v_lshlrev_b32 v63, 2, v0
    v_add_u32 v63, 43008, v63
    s_waitcnt lgkmcnt(0)
    s_barrier
    ds_read_b32 v64, v72 offset:39300
    ds_read_b32 v62, v63
    s_waitcnt lgkmcnt(1)
    v_cmp_lt_u32 s[60:61], v63, v64
    v_cmp_lt_u32 vcc, 45056, v64
    s_cbranch_vccnz L_ov_470
L_ovr_471:
    s_waitcnt lgkmcnt(0)
    v_lshrrev_b32 v82, 16, v62
    v_subrev_u32 v83, s96, v82
    v_subrev_u32 v82, s97, v82
    v_min_u32 v63, v82, v83
    v_cmp_gt_u32 vcc, s92, v63
    v_lshlrev_b32 v82, 1, v63
    s_and_b64 s[60:61], s[60:61], vcc
    s_cbranch_scc0 L_p2done
    s_mov_b64 exec, s[60:61]
    ds_add_rtn_u32 v64, v63, v86 offset:38528
    ds_read_b32 v65, v63 offset:37632
    ds_read_b64 v[66:67], v82 offset:35840
    v_mov_b32 v68, 0
    v_mov_b32 v69, 0
    s_waitcnt lgkmcnt(1)
    v_bfe_u32 v82, v65, 0, 5
    v_sub_u32 v83, 4, v82 clamp
    v_cmp_lt_u32 vcc, v64, v83
    v_add_u32 v82, v82, v64
    v_sub_u32 v64, v64, v83
    v_cndmask_b32 v69, v69, v82, vcc
    v_bfe_u32 v82, v65, 5, 5
    v_sub_u32 v83, 4, v82 clamp
    v_cmp_lt_u32 vcc, v64, v83
    v_add_u32 v82, v82, v64
    v_sub_u32 v64, v64, v83
    v_cndmask_b32 v69, v69, v82, vcc
    v_cndmask_b32 v68, v68, 1, vcc
    v_bfe_u32 v82, v65, 10, 5
    v_sub_u32 v83, 4, v82 clamp
    v_cmp_lt_u32 vcc, v64, v83
    v_add_u32 v82, v82, v64
    v_sub_u32 v64, v64, v83
    v_cndmask_b32 v69, v69, v82, vcc
    v_cndmask_b32 v68, v68, 2, vcc
    v_bfe_u32 v82, v65, 15, 5
    v_sub_u32 v83, 4, v82 clamp
    v_cmp_lt_u32 vcc, v64, v83
    v_add_u32 v82, v82, v64
    v_sub_u32 v64, v64, v83
    v_cndmask_b32 v69, v69, v82, vcc
    v_cndmask_b32 v68, v68, 3, vcc
    v_bfe_u32 v82, v65, 20, 5
    v_sub_u32 v83, 4, v82 clamp
    v_cmp_lt_u32 vcc, v64, v83
    v_add_u32 v82, v82, v64
    v_sub_u32 v64, v64, v83
    v_cndmask_b32 v69, v69, v82, vcc
    v_cndmask_b32 v68, v68, 4, vcc
    v_bfe_u32 v82, v65, 25, 5
    v_sub_u32 v83, 4, v82 clamp
    v_cmp_lt_u32 vcc, v64, v83
    v_add_u32 v82, v82, v64
    v_sub_u32 v64, v64, v83
    v_cndmask_b32 v69, v69, v82, vcc
    v_cndmask_b32 v68, v68, 5, vcc
    v_lshrrev_b32 v82, 2, v64
    v_add_u32 v82, 6, v82
    v_and_b32 v83, 3, v64
    v_cmp_le_i32 vcc, 0, v64
    s_nop 1
    v_cndmask_b32 v68, v68, v82, vcc
    v_cndmask_b32 v69, v69, v83, vcc
    v_lshrrev_b32 v82, 2, v68
    s_waitcnt lgkmcnt(0)
    v_mad_u32_u24 v82, v82, s93, v66
    v_lshl_add_u32 v82, v68, 1, v82
    v_lshl_add_u32 v82, v69, 6, v82
    v_subrev_u32 v66, 39424, v67
    v_lshrrev_b32 v66, 8, v66
    v_lshlrev_b32 v66, v66, v86
    v_lshlrev_b32 v65, 10, v66
    v_cmp_lt_u32 vcc, 7, v68
    s_nop 1
    v_cndmask_b32 v65, 0, v65, vcc
    v_or_b32 v66, v66, v65
    v_mov_b32 v65, 0x100000
    v_cmp_lt_u32 vcc, 9, v68
    s_nop 1
    v_cndmask_b32 v65, 0, v65, vcc
    v_or_b32 v66, v66, v65
    v_cmp_gt_u32 vcc, 12, v68
    s_nop 0
    s_and_b64 exec, s[60:61], vcc
    ds_write_b16 v82, v62
    s_mov_b64 exec, s[60:61]
    v_cmp_lt_u32 vcc, 5, v68
    s_nop 0
    s_and_b64 exec, exec, vcc
    ds_or_b32 v41, v66 offset:39296
    s_mov_b64 exec, -1
    s_nop 0
L_p2done:
    s_lshl_b32 s96, s77, 14
    s_add_u32 s96, s96, 6291456
    s_waitcnt lgkmcnt(0)
    s_barrier
    ds_read_b128 v[46:49], v43 offset:20480
    ds_read_b128 v[50:53], v43 offset:21504
    ds_read_b32 v22, v41 offset:39296
    s_lshl_b32 s97, s77, 7
    s_add_u32 s97, s97, 131072
    v_lshl_add_u32 v42, v1, 13, s97
    s_waitcnt lgkmcnt(2)
    v_xor_b32 v46, v46, v88
    v_xor_b32 v47, v47, v89
    v_xor_b32 v48, v48, v90
    v_xor_b32 v49, v49, v91
    s_waitcnt lgkmcnt(1)
    v_xor_b32 v50, v50, v88
    v_xor_b32 v51, v51, v89
    v_xor_b32 v52, v52, v90
    v_xor_b32 v53, v53, v91
    buffer_store_dwordx4 v[46:49], v43, s[4:7], s96 offen sc1
    s_mov_b32 exec_hi, 0xffffff
    buffer_store_dwordx4 v[50:53], v43, s[4:7], s96 offen offset:1024 sc1
    s_mov_b64 exec, -1
    s_waitcnt lgkmcnt(0)
    v_or_b32 v22, 0x80000000, v22
    s_cmp_lg_u32 s44, 7
    s_cbranch_scc1 L_nohdr
    s_mov_b64 exec, 0xff
    buffer_store_dwordx2 v[22:23], v42, s[4:7], 0 offen sc1
    s_mov_b64 exec, -1
L_nohdr:
    s_mov_b32 s41, 17
L_fill0:
    s_lshl_b32 s96, s49, 8
    v_lshlrev_b32 v41, 2, v1
    buffer_load_dword v30, v41, s[20:23], s96 offen
    s_lshl_b32 s96, s49, 6
    s_add_u32 s96, s96, 16384
    v_lshlrev_b32 v41, 1, v96
    buffer_load_ushort v32, v41, s[20:23], s96 offen
    s_lshl_b32 s96, s49, 7
    s_lshl_b32 s97, s45, 13
    s_add_u32 s96, s96, s97
    s_add_u32 s96, s96, 131072
    v_mov_b32 v43, s96
    s_bfe_u32 s96, s2, 0x30002
    s_lshl_b32 s96, s96, 12
    s_add_u32 s96, s96, 786432
    v_lshl_add_u32 v44, v1, 7, s96
    s_lshl_b32 s96, s47, 5
    s_add_u32 s96, s96, s48
    s_lshl_b32 s96, s96, 7
    s_add_u32 s96, s96, 786432
    v_mov_b32 v45, s96
    s_mov_b32 s52, 1
    s_lshl_b32 s96, s49, 10
    s_add_u32 s96, s96, 81920
    v_lshl_add_u32 v3, v1, 4, s96
    v_lshrrev_b32 v40, 3, v1
    v_lshlrev_b32 v40, 7, v40
    v_and_b32 v41, 7, v1
    v_lshl_add_u32 v40, v41, 3, v40
    s_lshl_b32 s96, s48, 10
    s_lshl_b32 s97, s44, 8
    s_add_u32 s96, s96, s97
    v_add_u32 v230, s96, v40
    s_cmp_eq_u32 s44, 7
    s_cselect_b64 vcc, -1, 0
    v_cndmask_b32 v230, v230, v44, vcc
    v_min_u32 v41, 16, v1
    v_and_b32 v40, 7, v41
    v_lshlrev_b32 v40, 9, v40
    v_lshrrev_b32 v41, 3, v41
    v_lshl_add_u32 v40, v41, 12, v40
    v_add_u32 v40, 790528, v40
    s_cmp_eq_u32 s44, 6
    s_cselect_b64 vcc, -1, 0
    v_cndmask_b32 v230, v230, v40, vcc
    s_mov_b32 s87, 0
    s_mov_b32 s42, 3
    s_mov_b32 s55, 4
    s_mov_b32 s56, 5
    s_mov_b32 s54, 11010048
    s_add_u32 s95, s47, 1
    s_and_b32 s95, s95, 7
    s_lshl_b32 s80, s95, 10
    s_add_u32 s95, s47, 2
    s_and_b32 s95, s95, 7
    s_lshl_b32 s81, s95, 10
    s_add_u32 s95, s47, 3
    s_and_b32 s95, s95, 7
    s_lshl_b32 s82, s95, 10
    s_add_u32 s95, s47, 4
    s_and_b32 s95, s95, 7
    s_lshl_b32 s83, s95, 10
    s_add_u32 s95, s47, 5
    s_and_b32 s95, s95, 7
    s_lshl_b32 s84, s95, 10
    s_add_u32 s95, s47, 6
    s_and_b32 s95, s95, 7
    s_lshl_b32 s85, s95, 10
    s_add_u32 s95, s47, 7
    s_and_b32 s95, s95, 7
    s_lshl_b32 s86, s95, 10
    s_mov_b32 s92, 0x200000
    s_mov_b32 s93, 0
    s_sub_u32 s58, 0, 0x80000000
    s_mov_b64 exec, 1
L_pl_472:
    buffer_load_dwordx2 v[94:95], v43, s[4:7], 0 offen sc1
    s_add_u32 s57, s57, 1
    s_cmp_gt_u32 s57, 4194304
    s_cbranch_scc1 L_end
    s_waitcnt vmcnt(0)
    v_lshl_add_u64 v[40:41], v[94:95], 0, s[58:59]
    v_cmp_le_u64 vcc, s[92:93], v[40:41]
    s_cbranch_vccnz L_pl_472
    s_mov_b64 exec, -1
    v_readfirstlane_b32 s51, v94
    v_lshlrev_b32 v43, 4, v1
    s_lshl_b32 s88, s49, 14
    s_add_u32 s88, s88, 6291456
    s_add_u32 s89, s88, 5120
    s_mov_b32 s78, 81920
    s_mov_b32 exec_hi, 0xff
    buffer_load_dwordx2 v[94:95], v39, s[4:7], 0 offen sc1
    s_mov_b64 exec, -1
    buffer_load_dwordx4 v[46:49], v43, s[4:7], s88 offen offset:0 sc1
    buffer_load_dwordx4 v[66:69], v43, s[4:7], s89 offen offset:0 sc1
    buffer_load_dwordx4 v[50:53], v43, s[4:7], s88 offen offset:1024 sc1
    buffer_load_dwordx4 v[70:73], v43, s[4:7], s89 offen offset:1024 sc1
    v_and_b32 v31, 0xffff0000, v30
    v_lshlrev_b32 v30, 16, v30
    v_lshlrev_b32 v32, 16, v32
    v_mov_b32 v42, 0
    v_mov_b32 v22, 3
    s_sub_u32 s58, 0, 1
    s_mov_b32 exec_hi, 0xff
    s_waitcnt vmcnt(4)
    v_lshl_add_u64 v[40:41], v[94:95], 0, s[58:59]
    v_cmp_le_u64 vcc, 64, v[40:41]
    s_cbranch_vccnz L_pl_474
L_pd_475:
    s_mov_b64 exec, -1
    v_subrev_u32 v41, 1, v94
    v_cmp_ne_u32 vcc, s99, v41
    v_mov_b32 v39, v230
    s_and_b32 s50, vcc_hi, 0xff
    s_mov_b32 m0, s100
    s_nop 0
    buffer_load_dwordx4 v35, s[4:7], s53 offen offset:0 sc1 lds
    buffer_load_dwordx4 v35, s[4:7], s53 offen offset:1024 sc1 lds
    buffer_load_dwordx4 v35, s[4:7], s53 offen offset:2048 sc1 lds
    buffer_load_dwordx4 v35, s[4:7], s53 offen offset:3072 sc1 lds
    s_add_u32 m0, s100, 4096
    s_add_u32 s92, s53, 4096
    buffer_load_dwordx4 v35, s[4:7], s92 offen offset:0 sc1 lds
    buffer_load_dwordx4 v35, s[4:7], s92 offen offset:1024 sc1 lds
    buffer_load_dwordx4 v35, s[4:7], s92 offen offset:2048 sc1 lds
    buffer_load_dwordx4 v35, s[4:7], s92 offen offset:3072 sc1 lds
    s_mul_i32 s92, s48, 81920
    s_lshl_b32 s93, s44, 11
    s_add_u32 m0, s93, 147456
    s_add_u32 s92, s92, s93
    s_add_u32 s92, s92, 1114112
    v_lshlrev_b32 v43, 4, v1
    buffer_load_dwordx4 v43, s[4:7], s92 offen offset:0 sc1 lds
    buffer_load_dwordx4 v43, s[4:7], s92 offen offset:1024 sc1 lds
    buffer_load_dwordx4 v[54:57], v43, s[4:7], s88 offen offset:2048 sc1
    buffer_load_dwordx4 v[74:77], v43, s[4:7], s89 offen offset:2048 sc1
    buffer_load_dwordx4 v[58:61], v43, s[4:7], s88 offen offset:3072 sc1
    buffer_load_dwordx4 v[78:81], v43, s[4:7], s89 offen offset:3072 sc1
    s_add_u32 s96, s88, 4096
    buffer_load_dwordx4 v[62:65], v43, s[4:7], s96 offen offset:0 sc1
    s_add_u32 s96, s89, 4096
    buffer_load_dwordx4 v[82:85], v43, s[4:7], s96 offen offset:0 sc1
    s_waitcnt vmcnt(6)
    s_barrier
    s_cmp_lg_u32 s50, 0
    s_cbranch_scc1 L_xs_477
    s_mov_b64 exec, 1
    buffer_store_dwordx2 v[22:23], v38, s[4:7], 0 offen
    s_mov_b64 exec, -1
L_xe_478:
    s_and_b32 s96, s51, 0x1ffc00
    s_cbranch_scc1 L_imp
    s_cmp_lt_u32 s44, 4
    s_cbranch_scc1 L_np_479
    s_setprio 1
L_np_479:
    s_waitcnt vmcnt(9)
    v_xor_b32 v46, v46, v88
    v_xor_b32 v47, v47, v89
    v_xor_b32 v48, v48, v90
    v_xor_b32 v49, v49, v91
    v_or3_b32 v42, v42, v46, v47
    v_or3_b32 v42, v42, v48, v49
    v_mad_u32_u16 v100, v46, 8, s78
    v_mad_u32_u16 v101, v46, 8, s78 op_sel:[1,0,0,0]
    v_mad_u32_u16 v102, v47, 8, s78
    v_mad_u32_u16 v103, v47, 8, s78 op_sel:[1,0,0,0]
    v_mad_u32_u16 v110, v48, 8, s78
    v_mad_u32_u16 v111, v48, 8, s78 op_sel:[1,0,0,0]
    v_mad_u32_u16 v112, v49, 8, s78
    v_mad_u32_u16 v113, v49, 8, s78 op_sel:[1,0,0,0]
    v_xor_b32 v66, v66, v88
    v_xor_b32 v67, v67, v89
    v_xor_b32 v68, v68, v90
    v_xor_b32 v69, v69, v91
    v_or3_b32 v42, v42, v66, v67
    v_or3_b32 v42, v42, v68, v69
    v_mad_u32_u16 v104, v66, 8, s78
    v_mad_u32_u16 v105, v66, 8, s78 op_sel:[1,0,0,0]
    v_mad_u32_u16 v106, v67, 8, s78
    v_mad_u32_u16 v107, v67, 8, s78 op_sel:[1,0,0,0]
    v_mad_u32_u16 v114, v68, 8, s78
    v_mad_u32_u16 v115, v68, 8, s78 op_sel:[1,0,0,0]
    v_mad_u32_u16 v116, v69, 8, s78
    v_mad_u32_u16 v117, v69, 8, s78 op_sel:[1,0,0,0]
    ds_read_b64_tr_b16 v[200:201], v100
    ds_read_b64_tr_b16 v[202:203], v101
    ds_read_b64_tr_b16 v[204:205], v102
    ds_read_b64_tr_b16 v[206:207], v103
    ds_read_b64_tr_b16 v[208:209], v104
    ds_read_b64_tr_b16 v[210:211], v105
    s_bitcmp1_b32 s51, 0
    s_cbranch_scc1 L_r_480
L_rr_481:
    ds_read_b64_tr_b16 v[220:221], v110
    ds_read_b64_tr_b16 v[222:223], v111
    ds_read_b64_tr_b16 v[224:225], v112
    ds_read_b64_tr_b16 v[226:227], v113
    ds_read_b64_tr_b16 v[228:229], v114
    ds_read_b64_tr_b16 v[230:231], v115
    s_bitcmp1_b32 s51, 1
    s_cbranch_scc1 L_r_482
L_rr_483:
    s_waitcnt lgkmcnt(6)
    v_mfma_f32_16x16x32_bf16 v[4:7], v[200:203], v[240:243], 0
    v_mfma_f32_16x16x32_bf16 v[4:7], v[204:207], v[240:243], v[4:7]
    v_mfma_f32_16x16x32_bf16 v[4:7], v[208:211], v[240:243], v[4:7]
    s_bitcmp1_b32 s51, 0
    s_cbranch_scc1 L_m_484
L_mr_485:
    s_waitcnt vmcnt(7)
    v_xor_b32 v50, v50, v88
    v_xor_b32 v51, v51, v89
    v_xor_b32 v52, v52, v90
    v_xor_b32 v53, v53, v91
    v_or3_b32 v42, v42, v50, v51
    v_or3_b32 v42, v42, v52, v53
    v_mad_u32_u16 v120, v50, 8, s78
    v_mad_u32_u16 v121, v50, 8, s78 op_sel:[1,0,0,0]
    v_mad_u32_u16 v122, v51, 8, s78
    v_mad_u32_u16 v123, v51, 8, s78 op_sel:[1,0,0,0]
    v_mad_u32_u16 v130, v52, 8, s78
    v_mad_u32_u16 v131, v52, 8, s78 op_sel:[1,0,0,0]
    v_mad_u32_u16 v132, v53, 8, s78
    v_mad_u32_u16 v133, v53, 8, s78 op_sel:[1,0,0,0]
    v_xor_b32 v70, v70, v88
    v_xor_b32 v71, v71, v89
    v_xor_b32 v72, v72, v90
    v_xor_b32 v73, v73, v91
    v_or3_b32 v42, v42, v70, v71
    v_or3_b32 v42, v42, v72, v73
    v_mad_u32_u16 v124, v70, 8, s78
    v_mad_u32_u16 v125, v70, 8, s78 op_sel:[1,0,0,0]
    v_mad_u32_u16 v126, v71, 8, s78
    v_mad_u32_u16 v127, v71, 8, s78 op_sel:[1,0,0,0]
    v_mad_u32_u16 v134, v72, 8, s78
    v_mad_u32_u16 v135, v72, 8, s78 op_sel:[1,0,0,0]
    v_mad_u32_u16 v136, v73, 8, s78
    v_mad_u32_u16 v137, v73, 8, s78 op_sel:[1,0,0,0]
    ds_read_b64_tr_b16 v[200:201], v120
    ds_read_b64_tr_b16 v[202:203], v121
    ds_read_b64_tr_b16 v[204:205], v122
    ds_read_b64_tr_b16 v[206:207], v123
    ds_read_b64_tr_b16 v[208:209], v124
    ds_read_b64_tr_b16 v[210:211], v125
    s_bitcmp1_b32 s51, 2
    s_cbranch_scc1 L_r_486
L_rr_487:
    s_waitcnt lgkmcnt(6)
    v_mfma_f32_16x16x32_bf16 v[4:7], v[220:223], v[244:247], v[4:7]
    v_mfma_f32_16x16x32_bf16 v[4:7], v[224:227], v[244:247], v[4:7]
    v_mfma_f32_16x16x32_bf16 v[4:7], v[228:231], v[244:247], v[4:7]
    s_bitcmp1_b32 s51, 1
    s_cbranch_scc1 L_m_488
L_mr_489:
    ds_read_b64_tr_b16 v[220:221], v130
    ds_read_b64_tr_b16 v[222:223], v131
    ds_read_b64_tr_b16 v[224:225], v132
    ds_read_b64_tr_b16 v[226:227], v133
    ds_read_b64_tr_b16 v[228:229], v134
    ds_read_b64_tr_b16 v[230:231], v135
    s_bitcmp1_b32 s51, 3
    s_cbranch_scc1 L_r_490
L_rr_491:
    s_waitcnt lgkmcnt(6)
    v_mfma_f32_16x16x32_bf16 v[4:7], v[200:203], v[248:251], v[4:7]
    v_mfma_f32_16x16x32_bf16 v[4:7], v[204:207], v[248:251], v[4:7]
    v_mfma_f32_16x16x32_bf16 v[4:7], v[208:211], v[248:251], v[4:7]
    s_bitcmp1_b32 s51, 2
    s_cbranch_scc1 L_m_492
L_mr_493:
    s_waitcnt vmcnt(5)
    v_xor_b32 v54, v54, v88
    v_xor_b32 v55, v55, v89
    v_xor_b32 v56, v56, v90
    v_xor_b32 v57, v57, v91
    v_or3_b32 v42, v42, v54, v55
    v_or3_b32 v42, v42, v56, v57
    v_mad_u32_u16 v140, v54, 8, s78
    v_mad_u32_u16 v141, v54, 8, s78 op_sel:[1,0,0,0]
    v_mad_u32_u16 v142, v55, 8, s78
    v_mad_u32_u16 v143, v55, 8, s78 op_sel:[1,0,0,0]
    v_mad_u32_u16 v150, v56, 8, s78
    v_mad_u32_u16 v151, v56, 8, s78 op_sel:[1,0,0,0]
    v_mad_u32_u16 v152, v57, 8, s78
    v_mad_u32_u16 v153, v57, 8, s78 op_sel:[1,0,0,0]
    v_xor_b32 v74, v74, v88
    v_xor_b32 v75, v75, v89
    v_xor_b32 v76, v76, v90
    v_xor_b32 v77, v77, v91
    v_or3_b32 v42, v42, v74, v75
    v_or3_b32 v42, v42, v76, v77
    v_mad_u32_u16 v144, v74, 8, s78
    v_mad_u32_u16 v145, v74, 8, s78 op_sel:[1,0,0,0]
    v_mad_u32_u16 v146, v75, 8, s78
    v_mad_u32_u16 v147, v75, 8, s78 op_sel:[1,0,0,0]
    v_mad_u32_u16 v154, v76, 8, s78
    v_mad_u32_u16 v155, v76, 8, s78 op_sel:[1,0,0,0]
    v_mad_u32_u16 v156, v77, 8, s78
    v_mad_u32_u16 v157, v77, 8, s78 op_sel:[1,0,0,0]
    ds_read_b64_tr_b16 v[200:201], v140
    ds_read_b64_tr_b16 v[202:203], v141
    ds_read_b64_tr_b16 v[204:205], v142
    ds_read_b64_tr_b16 v[206:207], v143
    ds_read_b64_tr_b16 v[208:209], v144
    ds_read_b64_tr_b16 v[210:211], v145
    s_bitcmp1_b32 s51, 4
    s_cbranch_scc1 L_r_494
L_rr_495:
    s_waitcnt lgkmcnt(6)
    v_mfma_f32_16x16x32_bf16 v[4:7], v[220:223], v[252:255], v[4:7]
    v_mfma_f32_16x16x32_bf16 v[4:7], v[224:227], v[252:255], v[4:7]
    v_mfma_f32_16x16x32_bf16 v[4:7], v[228:231], v[252:255], v[4:7]
    s_bitcmp1_b32 s51, 3
    s_cbranch_scc1 L_m_496
L_mr_497:
    ds_read_b64_tr_b16 v[220:221], v150
    ds_read_b64_tr_b16 v[222:223], v151
    ds_read_b64_tr_b16 v[224:225], v152
    ds_read_b64_tr_b16 v[226:227], v153
    ds_read_b64_tr_b16 v[228:229], v154
    ds_read_b64_tr_b16 v[230:231], v155
    s_bitcmp1_b32 s51, 5
    s_cbranch_scc1 L_r_498
L_rr_499:
    s_waitcnt lgkmcnt(6)
    v_mfma_f32_16x16x32_bf16 v[8:11], v[200:203], v[240:243], 0
    v_mfma_f32_16x16x32_bf16 v[8:11], v[204:207], v[240:243], v[8:11]
    v_mfma_f32_16x16x32_bf16 v[8:11], v[208:211], v[240:243], v[8:11]
    s_bitcmp1_b32 s51, 4
    s_cbranch_scc1 L_m_500
L_mr_501:
    v_mul_f32 v4, v4, v30
    v_mul_f32 v5, v5, v30
    v_mul_f32 v6, v6, v30
    v_mul_f32 v7, v7, v30
    v_cvt_pk_bf16_f32 v24, v4, v5
    v_cvt_pk_bf16_f32 v25, v6, v7
    v_lshlrev_b32 v4, 16, v24
    v_and_b32 v5, 0xffff0000, v24
    v_lshlrev_b32 v6, 16, v25
    v_and_b32 v7, 0xffff0000, v25
    v_mul_f32 v4, v4, v30
    v_mul_f32 v5, v5, v30
    v_mul_f32 v6, v6, v30
    v_mul_f32 v7, v7, v30
    v_cvt_pk_bf16_f32 v16, v4, v5
    v_cvt_pk_bf16_f32 v17, v6, v7
    s_mov_b64 exec, 0xff
    buffer_load_dwordx2 v[94:95], v37, s[4:7], 0 offen sc1
    s_mov_b64 exec, -1
    s_waitcnt vmcnt(4)
    v_xor_b32 v58, v58, v88
    v_xor_b32 v59, v59, v89
    v_xor_b32 v60, v60, v90
    v_xor_b32 v61, v61, v91
    v_or3_b32 v42, v42, v58, v59
    v_or3_b32 v42, v42, v60, v61
    v_mad_u32_u16 v160, v58, 8, s78
    v_mad_u32_u16 v161, v58, 8, s78 op_sel:[1,0,0,0]
    v_mad_u32_u16 v162, v59, 8, s78
    v_mad_u32_u16 v163, v59, 8, s78 op_sel:[1,0,0,0]
    v_mad_u32_u16 v170, v60, 8, s78
    v_mad_u32_u16 v171, v60, 8, s78 op_sel:[1,0,0,0]
    v_mad_u32_u16 v172, v61, 8, s78
    v_mad_u32_u16 v173, v61, 8, s78 op_sel:[1,0,0,0]
    v_xor_b32 v78, v78, v88
    v_xor_b32 v79, v79, v89
    v_xor_b32 v80, v80, v90
    v_xor_b32 v81, v81, v91
    v_or3_b32 v42, v42, v78, v79
    v_or3_b32 v42, v42, v80, v81
    v_mad_u32_u16 v164, v78, 8, s78
    v_mad_u32_u16 v165, v78, 8, s78 op_sel:[1,0,0,0]
    v_mad_u32_u16 v166, v79, 8, s78
    v_mad_u32_u16 v167, v79, 8, s78 op_sel:[1,0,0,0]
    v_mad_u32_u16 v174, v80, 8, s78
    v_mad_u32_u16 v175, v80, 8, s78 op_sel:[1,0,0,0]
    v_mad_u32_u16 v176, v81, 8, s78
    v_mad_u32_u16 v177, v81, 8, s78 op_sel:[1,0,0,0]
    ds_read_b64_tr_b16 v[200:201], v160
    ds_read_b64_tr_b16 v[202:203], v161
    ds_read_b64_tr_b16 v[204:205], v162
    ds_read_b64_tr_b16 v[206:207], v163
    ds_read_b64_tr_b16 v[208:209], v164
    ds_read_b64_tr_b16 v[210:211], v165
    s_bitcmp1_b32 s51, 6
    s_cbranch_scc1 L_r_502
L_rr_503:
    s_waitcnt lgkmcnt(6)
    v_mfma_f32_16x16x32_bf16 v[8:11], v[220:223], v[244:247], v[8:11]
    v_mfma_f32_16x16x32_bf16 v[8:11], v[224:227], v[244:247], v[8:11]
    v_mfma_f32_16x16x32_bf16 v[8:11], v[228:231], v[244:247], v[8:11]
    s_bitcmp1_b32 s51, 5
    s_cbranch_scc1 L_m_504
L_mr_505:
    s_setprio 0
    ds_read_b64_tr_b16 v[220:221], v170
    ds_read_b64_tr_b16 v[222:223], v171
    ds_read_b64_tr_b16 v[224:225], v172
    ds_read_b64_tr_b16 v[226:227], v173
    ds_read_b64_tr_b16 v[228:229], v174
    ds_read_b64_tr_b16 v[230:231], v175
    s_bitcmp1_b32 s51, 7
    s_cbranch_scc1 L_r_506
L_rr_507:
    s_waitcnt lgkmcnt(6)
    v_mfma_f32_16x16x32_bf16 v[8:11], v[200:203], v[248:251], v[8:11]
    v_mfma_f32_16x16x32_bf16 v[8:11], v[204:207], v[248:251], v[8:11]
    v_mfma_f32_16x16x32_bf16 v[8:11], v[208:211], v[248:251], v[8:11]
    s_bitcmp1_b32 s51, 6
    s_cbranch_scc1 L_m_508
L_mr_509:
    s_waitcnt vmcnt(2)
    v_xor_b32 v62, v62, v88
    v_xor_b32 v63, v63, v89
    v_xor_b32 v64, v64, v90
    v_xor_b32 v65, v65, v91
    v_or3_b32 v42, v42, v62, v63
    v_or3_b32 v42, v42, v64, v65
    v_mad_u32_u16 v180, v62, 8, s78
    v_mad_u32_u16 v181, v62, 8, s78 op_sel:[1,0,0,0]
    v_mad_u32_u16 v182, v63, 8, s78
    v_mad_u32_u16 v183, v63, 8, s78 op_sel:[1,0,0,0]
    v_mad_u32_u16 v190, v64, 8, s78
    v_mad_u32_u16 v191, v64, 8, s78 op_sel:[1,0,0,0]
    v_mad_u32_u16 v192, v65, 8, s78
    v_mad_u32_u16 v193, v65, 8, s78 op_sel:[1,0,0,0]
    v_xor_b32 v82, v82, v88
    v_xor_b32 v83, v83, v89
    v_xor_b32 v84, v84, v90
    v_xor_b32 v85, v85, v91
    v_or3_b32 v42, v42, v82, v83
    v_or3_b32 v42, v42, v84, v85
    v_mad_u32_u16 v184, v82, 8, s78
    v_mad_u32_u16 v185, v82, 8, s78 op_sel:[1,0,0,0]
    v_mad_u32_u16 v186, v83, 8, s78
    v_mad_u32_u16 v187, v83, 8, s78 op_sel:[1,0,0,0]
    v_mad_u32_u16 v194, v84, 8, s78
    v_mad_u32_u16 v195, v84, 8, s78 op_sel:[1,0,0,0]
    v_mad_u32_u16 v196, v85, 8, s78
    v_mad_u32_u16 v197, v85, 8, s78 op_sel:[1,0,0,0]
    ds_read_b64_tr_b16 v[200:201], v180
    ds_read_b64_tr_b16 v[202:203], v181
    ds_read_b64_tr_b16 v[204:205], v182
    ds_read_b64_tr_b16 v[206:207], v183
    ds_read_b64_tr_b16 v[208:209], v184
    ds_read_b64_tr_b16 v[210:211], v185
    s_bitcmp1_b32 s51, 8
    s_cbranch_scc1 L_r_510
L_rr_511:
    s_waitcnt lgkmcnt(6)
    v_mfma_f32_16x16x32_bf16 v[8:11], v[220:223], v[252:255], v[8:11]
    v_mfma_f32_16x16x32_bf16 v[8:11], v[224:227], v[252:255], v[8:11]
    v_mfma_f32_16x16x32_bf16 v[8:11], v[228:231], v[252:255], v[8:11]
    s_bitcmp1_b32 s51, 7
    s_cbranch_scc1 L_m_512
L_mr_513:
    s_nop 7
    v_mul_f32 v8, v8, v31
    v_mul_f32 v9, v9, v31
    v_mul_f32 v10, v10, v31
    v_mul_f32 v11, v11, v31
    v_cvt_pk_bf16_f32 v26, v8, v9
    v_cvt_pk_bf16_f32 v27, v10, v11
    v_lshlrev_b32 v8, 16, v26
    v_and_b32 v9, 0xffff0000, v26
    v_lshlrev_b32 v10, 16, v27
    v_and_b32 v11, 0xffff0000, v27
    v_mul_f32 v8, v8, v31
    v_mul_f32 v9, v9, v31
    v_mul_f32 v10, v10, v31
    v_mul_f32 v11, v11, v31
    v_cvt_pk_bf16_f32 v18, v8, v9
    v_cvt_pk_bf16_f32 v19, v10, v11
    s_waitcnt vmcnt(0)
    v_and_b32 v42, 0xc000c000, v42
    v_cmp_ne_u32 vcc, 0, v42
    s_cbranch_vccnz L_impagain
    s_sub_u32 s58, 0, s42
    s_mov_b64 exec, 255
    v_lshl_add_u64 v[40:41], v[94:95], 0, s[58:59]
    v_cmp_le_u64 vcc, 64, v[40:41]
    s_cbranch_vccnz L_pl_514
L_pd_515:
    s_mov_b64 exec, -1
    s_cmp_lg_u32 s50, 0
    s_cbranch_scc1 L_xs_516
    buffer_store_dwordx4 v[16:19], v33, s[4:7], s53 offen
L_xe_517:
    ds_read_b64_tr_b16 v[220:221], v190
    ds_read_b64_tr_b16 v[222:223], v191
    ds_read_b64_tr_b16 v[224:225], v192
    ds_read_b64_tr_b16 v[226:227], v193
    ds_read_b64_tr_b16 v[228:229], v194
    ds_read_b64_tr_b16 v[230:231], v195
    s_bitcmp1_b32 s51, 9
    s_cbranch_scc1 L_r_518
L_rr_519:
    s_waitcnt lgkmcnt(6)
    v_mfma_f32_16x16x32_bf16 v[12:15], v[200:203], v[240:243], 0
    v_mfma_f32_16x16x32_bf16 v[12:15], v[204:207], v[240:243], v[12:15]
    v_mfma_f32_16x16x32_bf16 v[12:15], v[208:211], v[240:243], v[12:15]
    s_bitcmp1_b32 s51, 8
    s_cbranch_scc1 L_m_520
L_mr_521:
    v_mov_b32 v22, s55
    s_waitcnt vmcnt(0)
    s_cmp_lg_u32 s50, 0
    s_cbranch_scc1 L_xs_522
    s_mov_b64 exec, 1
    buffer_store_dwordx2 v[22:23], v38, s[4:7], 0 offen
    s_mov_b64 exec, -1
L_xe_523:
    s_waitcnt lgkmcnt(0)
    v_mfma_f32_16x16x32_bf16 v[12:15], v[220:223], v[244:247], v[12:15]
    v_mfma_f32_16x16x32_bf16 v[12:15], v[224:227], v[244:247], v[12:15]
    v_mfma_f32_16x16x32_bf16 v[12:15], v[228:231], v[244:247], v[12:15]
    s_bitcmp1_b32 s51, 9
    s_cbranch_scc1 L_m_524
L_mr_525:
    s_branch L_gath_done
    s_nop 6
L_impagain:
    s_add_u32 s57, s57, 1
    s_cmp_gt_u32 s57, 4194304
    s_cbranch_scc1 L_end
    s_setprio 0
    s_waitcnt vmcnt(0) lgkmcnt(0)
    buffer_load_dwordx4 v[46:49], v43, s[4:7], s88 offen offset:0 sc1
    buffer_load_dwordx4 v[66:69], v43, s[4:7], s89 offen offset:0 sc1
    buffer_load_dwordx4 v[50:53], v43, s[4:7], s88 offen offset:1024 sc1
    buffer_load_dwordx4 v[70:73], v43, s[4:7], s89 offen offset:1024 sc1
    buffer_load_dwordx4 v[54:57], v43, s[4:7], s88 offen offset:2048 sc1
    buffer_load_dwordx4 v[74:77], v43, s[4:7], s89 offen offset:2048 sc1
    buffer_load_dwordx4 v[58:61], v43, s[4:7], s88 offen offset:3072 sc1
    buffer_load_dwordx4 v[78:81], v43, s[4:7], s89 offen offset:3072 sc1
    s_add_u32 s96, s88, 4096
    buffer_load_dwordx4 v[62:65], v43, s[4:7], s96 offen offset:0 sc1
    s_add_u32 s96, s89, 4096
    buffer_load_dwordx4 v[82:85], v43, s[4:7], s96 offen offset:0 sc1
L_imp:
    s_add_u32 s96, s88, 10240
    s_add_u32 s97, s88, 14336
    v_mov_b32 v42, 0
    buffer_load_dwordx4 v[200:203], v43, s[4:7], s96 offen offset:0 sc1
    buffer_load_dwordx4 v[204:207], v43, s[4:7], s96 offen offset:1024 sc1
    buffer_load_dwordx4 v[208:211], v43, s[4:7], s96 offen offset:2048 sc1
    buffer_load_dwordx4 v[212:215], v43, s[4:7], s96 offen offset:3072 sc1
    buffer_load_dwordx4 v[216:219], v43, s[4:7], s97 offen offset:0 sc1
    s_waitcnt vmcnt(0)
    v_xor_b32 v46, v46, v88
    v_xor_b32 v47, v47, v89
    v_xor_b32 v48, v48, v90
    v_xor_b32 v49, v49, v91
    v_or3_b32 v42, v42, v46, v47
    v_or3_b32 v42, v42, v48, v49
    v_mad_u32_u16 v100, v46, 8, s78
    v_mad_u32_u16 v101, v46, 8, s78 op_sel:[1,0,0,0]
    v_mad_u32_u16 v102, v47, 8, s78
    v_mad_u32_u16 v103, v47, 8, s78 op_sel:[1,0,0,0]
    v_mad_u32_u16 v110, v48, 8, s78
    v_mad_u32_u16 v111, v48, 8, s78 op_sel:[1,0,0,0]
    v_mad_u32_u16 v112, v49, 8, s78
    v_mad_u32_u16 v113, v49, 8, s78 op_sel:[1,0,0,0]
    v_xor_b32 v50, v50, v88
    v_xor_b32 v51, v51, v89
    v_xor_b32 v52, v52, v90
    v_xor_b32 v53, v53, v91
    v_or3_b32 v42, v42, v50, v51
    v_or3_b32 v42, v42, v52, v53
    v_mad_u32_u16 v120, v50, 8, s78
    v_mad_u32_u16 v121, v50, 8, s78 op_sel:[1,0,0,0]
    v_mad_u32_u16 v122, v51, 8, s78
    v_mad_u32_u16 v123, v51, 8, s78 op_sel:[1,0,0,0]
    v_mad_u32_u16 v130, v52, 8, s78
    v_mad_u32_u16 v131, v52, 8, s78 op_sel:[1,0,0,0]
    v_mad_u32_u16 v132, v53, 8, s78
    v_mad_u32_u16 v133, v53, 8, s78 op_sel:[1,0,0,0]
    v_xor_b32 v54, v54, v88
    v_xor_b32 v55, v55, v89
    v_xor_b32 v56, v56, v90
    v_xor_b32 v57, v57, v91
    v_or3_b32 v42, v42, v54, v55
    v_or3_b32 v42, v42, v56, v57
    v_mad_u32_u16 v140, v54, 8, s78
    v_mad_u32_u16 v141, v54, 8, s78 op_sel:[1,0,0,0]
    v_mad_u32_u16 v142, v55, 8, s78
    v_mad_u32_u16 v143, v55, 8, s78 op_sel:[1,0,0,0]
    v_mad_u32_u16 v150, v56, 8, s78
    v_mad_u32_u16 v151, v56, 8, s78 op_sel:[1,0,0,0]
    v_mad_u32_u16 v152, v57, 8, s78
    v_mad_u32_u16 v153, v57, 8, s78 op_sel:[1,0,0,0]
    v_xor_b32 v58, v58, v88
    v_xor_b32 v59, v59, v89
    v_xor_b32 v60, v60, v90
    v_xor_b32 v61, v61, v91
    v_or3_b32 v42, v42, v58, v59
    v_or3_b32 v42, v42, v60, v61
    v_mad_u32_u16 v160, v58, 8, s78
    v_mad_u32_u16 v161, v58, 8, s78 op_sel:[1,0,0,0]
    v_mad_u32_u16 v162, v59, 8, s78
    v_mad_u32_u16 v163, v59, 8, s78 op_sel:[1,0,0,0]
    v_mad_u32_u16 v170, v60, 8, s78
    v_mad_u32_u16 v171, v60, 8, s78 op_sel:[1,0,0,0]
    v_mad_u32_u16 v172, v61, 8, s78
    v_mad_u32_u16 v173, v61, 8, s78 op_sel:[1,0,0,0]
    v_xor_b32 v62, v62, v88
    v_xor_b32 v63, v63, v89
    v_xor_b32 v64, v64, v90
    v_xor_b32 v65, v65, v91
    v_or3_b32 v42, v42, v62, v63
    v_or3_b32 v42, v42, v64, v65
    v_mad_u32_u16 v180, v62, 8, s78
    v_mad_u32_u16 v181, v62, 8, s78 op_sel:[1,0,0,0]
    v_mad_u32_u16 v182, v63, 8, s78
    v_mad_u32_u16 v183, v63, 8, s78 op_sel:[1,0,0,0]
    v_mad_u32_u16 v190, v64, 8, s78
    v_mad_u32_u16 v191, v64, 8, s78 op_sel:[1,0,0,0]
    v_mad_u32_u16 v192, v65, 8, s78
    v_mad_u32_u16 v193, v65, 8, s78 op_sel:[1,0,0,0]
    v_xor_b32 v66, v66, v88
    v_xor_b32 v67, v67, v89
    v_xor_b32 v68, v68, v90
    v_xor_b32 v69, v69, v91
    v_or3_b32 v42, v42, v66, v67
    v_or3_b32 v42, v42, v68, v69
    v_mad_u32_u16 v104, v66, 8, s78
    v_mad_u32_u16 v105, v66, 8, s78 op_sel:[1,0,0,0]
    v_mad_u32_u16 v106, v67, 8, s78
    v_mad_u32_u16 v107, v67, 8, s78 op_sel:[1,0,0,0]
    v_mad_u32_u16 v114, v68, 8, s78
    v_mad_u32_u16 v115, v68, 8, s78 op_sel:[1,0,0,0]
    v_mad_u32_u16 v116, v69, 8, s78
    v_mad_u32_u16 v117, v69, 8, s78 op_sel:[1,0,0,0]
    v_xor_b32 v70, v70, v88
    v_xor_b32 v71, v71, v89
    v_xor_b32 v72, v72, v90
    v_xor_b32 v73, v73, v91
    v_or3_b32 v42, v42, v70, v71
    v_or3_b32 v42, v42, v72, v73
    v_mad_u32_u16 v124, v70, 8, s78
    v_mad_u32_u16 v125, v70, 8, s78 op_sel:[1,0,0,0]
    v_mad_u32_u16 v126, v71, 8, s78
    v_mad_u32_u16 v127, v71, 8, s78 op_sel:[1,0,0,0]
    v_mad_u32_u16 v134, v72, 8, s78
    v_mad_u32_u16 v135, v72, 8, s78 op_sel:[1,0,0,0]
    v_mad_u32_u16 v136, v73, 8, s78
    v_mad_u32_u16 v137, v73, 8, s78 op_sel:[1,0,0,0]
    v_xor_b32 v74, v74, v88
    v_xor_b32 v75, v75, v89
    v_xor_b32 v76, v76, v90
    v_xor_b32 v77, v77, v91
    v_or3_b32 v42, v42, v74, v75
    v_or3_b32 v42, v42, v76, v77
    v_mad_u32_u16 v144, v74, 8, s78
    v_mad_u32_u16 v145, v74, 8, s78 op_sel:[1,0,0,0]
    v_mad_u32_u16 v146, v75, 8, s78
    v_mad_u32_u16 v147, v75, 8, s78 op_sel:[1,0,0,0]
    v_mad_u32_u16 v154, v76, 8, s78
    v_mad_u32_u16 v155, v76, 8, s78 op_sel:[1,0,0,0]
    v_mad_u32_u16 v156, v77, 8, s78
    v_mad_u32_u16 v157, v77, 8, s78 op_sel:[1,0,0,0]
    v_xor_b32 v78, v78, v88
    v_xor_b32 v79, v79, v89
    v_xor_b32 v80, v80, v90
    v_xor_b32 v81, v81, v91
    v_or3_b32 v42, v42, v78, v79
    v_or3_b32 v42, v42, v80, v81
    v_mad_u32_u16 v164, v78, 8, s78
    v_mad_u32_u16 v165, v78, 8, s78 op_sel:[1,0,0,0]
    v_mad_u32_u16 v166, v79, 8, s78
    v_mad_u32_u16 v167, v79, 8, s78 op_sel:[1,0,0,0]
    v_mad_u32_u16 v174, v80, 8, s78
    v_mad_u32_u16 v175, v80, 8, s78 op_sel:[1,0,0,0]
    v_mad_u32_u16 v176, v81, 8, s78
    v_mad_u32_u16 v177, v81, 8, s78 op_sel:[1,0,0,0]
    v_xor_b32 v82, v82, v88
    v_xor_b32 v83, v83, v89
    v_xor_b32 v84, v84, v90
    v_xor_b32 v85, v85, v91
    v_or3_b32 v42, v42, v82, v83
    v_or3_b32 v42, v42, v84, v85
    v_mad_u32_u16 v184, v82, 8, s78
    v_mad_u32_u16 v185, v82, 8, s78 op_sel:[1,0,0,0]
    v_mad_u32_u16 v186, v83, 8, s78
    v_mad_u32_u16 v187, v83, 8, s78 op_sel:[1,0,0,0]
    v_mad_u32_u16 v194, v84, 8, s78
    v_mad_u32_u16 v195, v84, 8, s78 op_sel:[1,0,0,0]
    v_mad_u32_u16 v196, v85, 8, s78
    v_mad_u32_u16 v197, v85, 8, s78 op_sel:[1,0,0,0]
    v_xor_b32 v200, v200, v88
    v_xor_b32 v201, v201, v89
    v_xor_b32 v202, v202, v90
    v_xor_b32 v203, v203, v91
    v_or3_b32 v42, v42, v200, v201
    v_or3_b32 v42, v42, v202, v203
    v_mad_u32_u16 v108, v200, 8, s78
    v_mad_u32_u16 v109, v200, 8, s78 op_sel:[1,0,0,0]
    v_mad_u32_u16 v118, v202, 8, s78
    v_mad_u32_u16 v119, v202, 8, s78 op_sel:[1,0,0,0]
    v_xor_b32 v204, v204, v88
    v_xor_b32 v205, v205, v89
    v_xor_b32 v206, v206, v90
    v_xor_b32 v207, v207, v91
    v_or3_b32 v42, v42, v204, v205
    v_or3_b32 v42, v42, v206, v207
    v_mad_u32_u16 v128, v204, 8, s78
    v_mad_u32_u16 v129, v204, 8, s78 op_sel:[1,0,0,0]
    v_mad_u32_u16 v138, v206, 8, s78
    v_mad_u32_u16 v139, v206, 8, s78 op_sel:[1,0,0,0]
    v_xor_b32 v208, v208, v88
    v_xor_b32 v209, v209, v89
    v_xor_b32 v210, v210, v90
    v_xor_b32 v211, v211, v91
    v_or3_b32 v42, v42, v208, v209
    v_or3_b32 v42, v42, v210, v211
    v_mad_u32_u16 v148, v208, 8, s78
    v_mad_u32_u16 v149, v208, 8, s78 op_sel:[1,0,0,0]
    v_mad_u32_u16 v158, v210, 8, s78
    v_mad_u32_u16 v159, v210, 8, s78 op_sel:[1,0,0,0]
    v_xor_b32 v212, v212, v88
    v_xor_b32 v213, v213, v89
    v_xor_b32 v214, v214, v90
    v_xor_b32 v215, v215, v91
    v_or3_b32 v42, v42, v212, v213
    v_or3_b32 v42, v42, v214, v215
    v_mad_u32_u16 v168, v212, 8, s78
    v_mad_u32_u16 v169, v212, 8, s78 op_sel:[1,0,0,0]
    v_mad_u32_u16 v178, v214, 8, s78
    v_mad_u32_u16 v179, v214, 8, s78 op_sel:[1,0,0,0]
    v_xor_b32 v216, v216, v88
    v_xor_b32 v217, v217, v89
    v_xor_b32 v218, v218, v90
    v_xor_b32 v219, v219, v91
    v_or3_b32 v42, v42, v216, v217
    v_or3_b32 v42, v42, v218, v219
    v_mad_u32_u16 v188, v216, 8, s78
    v_mad_u32_u16 v189, v216, 8, s78 op_sel:[1,0,0,0]
    v_mad_u32_u16 v198, v218, 8, s78
    v_mad_u32_u16 v199, v218, 8, s78 op_sel:[1,0,0,0]
    v_and_b32 v42, 0xc000c000, v42
    v_cmp_ne_u32 vcc, 0, v42
    s_cbranch_vccnz L_impagain
    s_branch L_hop1b
    s_nop 2
L_hop:
    s_mul_i32 s42, s52, 3
    s_add_u32 s55, s42, 1
    s_add_u32 s56, s42, 2
    v_mov_b32 v22, s42
    s_cmp_lg_u32 s50, 0
    s_cbranch_scc1 L_xs_526
    s_mov_b64 exec, 1
    buffer_store_dwordx2 v[22:23], v38, s[4:7], 0 offen
    s_mov_b64 exec, -1
L_xe_527:
    s_sub_u32 s93, s52, 2
    buffer_store_dwordx4 v[24:27], v33, s[4:7], s54 offen sc1
    buffer_store_dwordx2 v[28:29], v34, s[4:7], s54 offen sc1
    v_mov_b32 v22, s93
    s_cmp_lg_u32 s44, 0
    s_cbranch_scc1 L_notf
    s_lshl_b32 s93, s93, 15
    s_mov_b64 exec, 1
    buffer_store_dwordx2 v[22:23], v45, s[4:7], s93 offen sc1
    s_mov_b64 exec, -1
L_notf:
    s_cmp_eq_u32 s52, 2
    s_cbranch_scc1 L_hop2x
    s_cmp_lt_u32 s52, 4
    s_cbranch_scc1 L_hop1
    s_sub_u32 s87, s52, 3
    s_cmp_eq_u32 s52, 7
    s_cselect_b32 s87, 5, s87
    s_cmp_eq_u32 s44, 7
    s_cselect_b32 s87, s87, 0
    s_lshl_b32 s92, s44, 3
    s_add_u32 s92, s92, s52
    s_cmp_eq_u32 s92, 55
    s_cselect_b32 s87, 4, s87
    s_lshl_b32 s40, s87, 15
    s_lshl_b32 s92, s52, 8
    s_add_u32 s92, s92, s41
    s_sub_u32 s92, s92, 0x500
    s_cmp_lt_u32 s92, 16
    s_cbranch_scc1 L_prepD
L_prepDr:
    s_cmp_gt_u32 s52, 4
    s_cbranch_scc1 L_stg
L_stgr:
    s_cmp_lg_u32 s87, 0
    s_cbranch_scc1 L_tpl
L_hop1:
    s_add_u32 s54, s54, 2621440
L_hop1b:
    s_bitcmp1_b32 s51, 20
    s_cbranch_scc1 L_slow
    s_cmp_lt_u32 s44, 4
    s_cbranch_scc1 L_np_529
    s_setprio 1
L_np_529:
    ds_read_b64_tr_b16 v[200:201], v100
    ds_read_b64_tr_b16 v[202:203], v101
    ds_read_b64_tr_b16 v[204:205], v102
    ds_read_b64_tr_b16 v[206:207], v103
    ds_read_b64_tr_b16 v[208:209], v104
    ds_read_b64_tr_b16 v[210:211], v105
    s_bitcmp1_b32 s51, 0
    s_cbranch_scc1 L_r_530
L_rr_531:
    ds_read_b64_tr_b16 v[220:221], v110
    ds_read_b64_tr_b16 v[222:223], v111
    ds_read_b64_tr_b16 v[224:225], v112
    ds_read_b64_tr_b16 v[226:227], v113
    ds_read_b64_tr_b16 v[228:229], v114
    ds_read_b64_tr_b16 v[230:231], v115
    s_bitcmp1_b32 s51, 1
    s_cbranch_scc1 L_r_532
L_rr_533:
    s_waitcnt lgkmcnt(6)
    v_mfma_f32_16x16x32_bf16 v[4:7], v[200:203], v[240:243], 0
    v_mfma_f32_16x16x32_bf16 v[4:7], v[204:207], v[240:243], v[4:7]
    v_mfma_f32_16x16x32_bf16 v[4:7], v[208:211], v[240:243], v[4:7]
    s_bitcmp1_b32 s51, 0
    s_cbranch_scc1 L_m_534
L_mr_535:
    ds_read_b64_tr_b16 v[200:201], v120
    ds_read_b64_tr_b16 v[202:203], v121
    ds_read_b64_tr_b16 v[204:205], v122
    ds_read_b64_tr_b16 v[206:207], v123
    ds_read_b64_tr_b16 v[208:209], v124
    ds_read_b64_tr_b16 v[210:211], v125
    s_bitcmp1_b32 s51, 2
    s_cbranch_scc1 L_r_536
L_rr_537:
    s_waitcnt lgkmcnt(6)
    v_mfma_f32_16x16x32_bf16 v[4:7], v[220:223], v[244:247], v[4:7]
    v_mfma_f32_16x16x32_bf16 v[4:7], v[224:227], v[244:247], v[4:7]
    v_mfma_f32_16x16x32_bf16 v[4:7], v[228:231], v[244:247], v[4:7]
    s_bitcmp1_b32 s51, 1
    s_cbranch_scc1 L_m_538
L_mr_539:
    ds_read_b64_tr_b16 v[220:221], v130
    ds_read_b64_tr_b16 v[222:223], v131
    ds_read_b64_tr_b16 v[224:225], v132
    ds_read_b64_tr_b16 v[226:227], v133
    ds_read_b64_tr_b16 v[228:229], v134
    ds_read_b64_tr_b16 v[230:231], v135
    s_bitcmp1_b32 s51, 3
    s_cbranch_scc1 L_r_540
L_rr_541:
    s_waitcnt lgkmcnt(6)
    v_mfma_f32_16x16x32_bf16 v[4:7], v[200:203], v[248:251], v[4:7]
    v_mfma_f32_16x16x32_bf16 v[4:7], v[204:207], v[248:251], v[4:7]
    v_mfma_f32_16x16x32_bf16 v[4:7], v[208:211], v[248:251], v[4:7]
    s_bitcmp1_b32 s51, 2
    s_cbranch_scc1 L_m_542
L_mr_543:
    ds_read_b64_tr_b16 v[200:201], v140
    ds_read_b64_tr_b16 v[202:203], v141
    ds_read_b64_tr_b16 v[204:205], v142
    ds_read_b64_tr_b16 v[206:207], v143
    ds_read_b64_tr_b16 v[208:209], v144
    ds_read_b64_tr_b16 v[210:211], v145
    s_bitcmp1_b32 s51, 4
    s_cbranch_scc1 L_r_544
L_rr_545:
    s_waitcnt lgkmcnt(6)
    v_mfma_f32_16x16x32_bf16 v[4:7], v[220:223], v[252:255], v[4:7]
    v_mfma_f32_16x16x32_bf16 v[4:7], v[224:227], v[252:255], v[4:7]
    v_mfma_f32_16x16x32_bf16 v[4:7], v[228:231], v[252:255], v[4:7]
    s_bitcmp1_b32 s51, 3
    s_cbranch_scc1 L_m_546
L_mr_547:
    ds_read_b64_tr_b16 v[220:221], v150
    ds_read_b64_tr_b16 v[222:223], v151
    ds_read_b64_tr_b16 v[224:225], v152
    ds_read_b64_tr_b16 v[226:227], v153
    ds_read_b64_tr_b16 v[228:229], v154
    ds_read_b64_tr_b16 v[230:231], v155
    s_bitcmp1_b32 s51, 5
    s_cbranch_scc1 L_r_548
L_rr_549:
    s_waitcnt lgkmcnt(6)
    v_mfma_f32_16x16x32_bf16 v[8:11], v[200:203], v[240:243], 0
    v_mfma_f32_16x16x32_bf16 v[8:11], v[204:207], v[240:243], v[8:11]
    v_mfma_f32_16x16x32_bf16 v[8:11], v[208:211], v[240:243], v[8:11]
    s_bitcmp1_b32 s51, 4
    s_cbranch_scc1 L_m_550
L_mr_551:
    s_cmp_eq_u32 s52, 7
    s_cbranch_scc1 L_a7_552
    v_mul_f32 v4, v4, v30
    v_mul_f32 v5, v5, v30
    v_mul_f32 v6, v6, v30
    v_mul_f32 v7, v7, v30
    v_cvt_pk_bf16_f32 v24, v4, v5
    v_cvt_pk_bf16_f32 v25, v6, v7
    v_lshlrev_b32 v4, 16, v24
    v_and_b32 v5, 0xffff0000, v24
    v_lshlrev_b32 v6, 16, v25
    v_and_b32 v7, 0xffff0000, v25
    v_mul_f32 v4, v4, v30
    v_mul_f32 v5, v5, v30
    v_mul_f32 v6, v6, v30
    v_mul_f32 v7, v7, v30
    v_cvt_pk_bf16_f32 v16, v4, v5
    v_cvt_pk_bf16_f32 v17, v6, v7
    s_mov_b64 exec, 0xff
    buffer_load_dwordx2 v[94:95], v37, s[4:7], 0 offen sc1
    s_mov_b64 exec, -1
L_a7r_553:
    ds_read_b64_tr_b16 v[200:201], v160
    ds_read_b64_tr_b16 v[202:203], v161
    ds_read_b64_tr_b16 v[204:205], v162
    ds_read_b64_tr_b16 v[206:207], v163
    ds_read_b64_tr_b16 v[208:209], v164
    ds_read_b64_tr_b16 v[210:211], v165
    s_bitcmp1_b32 s51, 6
    s_cbranch_scc1 L_r_554
L_rr_555:
    s_waitcnt lgkmcnt(6)
    v_mfma_f32_16x16x32_bf16 v[8:11], v[220:223], v[244:247], v[8:11]
    v_mfma_f32_16x16x32_bf16 v[8:11], v[224:227], v[244:247], v[8:11]
    v_mfma_f32_16x16x32_bf16 v[8:11], v[228:231], v[244:247], v[8:11]
    s_bitcmp1_b32 s51, 5
    s_cbranch_scc1 L_m_556
L_mr_557:
    s_setprio 0
    ds_read_b64_tr_b16 v[220:221], v170
    ds_read_b64_tr_b16 v[222:223], v171
    ds_read_b64_tr_b16 v[224:225], v172
    ds_read_b64_tr_b16 v[226:227], v173
    ds_read_b64_tr_b16 v[228:229], v174
    ds_read_b64_tr_b16 v[230:231], v175
    s_bitcmp1_b32 s51, 7
    s_cbranch_scc1 L_r_558
L_rr_559:
    s_waitcnt lgkmcnt(6)
    v_mfma_f32_16x16x32_bf16 v[8:11], v[200:203], v[248:251], v[8:11]
    v_mfma_f32_16x16x32_bf16 v[8:11], v[204:207], v[248:251], v[8:11]
    v_mfma_f32_16x16x32_bf16 v[8:11], v[208:211], v[248:251], v[8:11]
    s_bitcmp1_b32 s51, 6
    s_cbranch_scc1 L_m_560
L_mr_561:
    ds_read_b64_tr_b16 v[200:201], v180
    ds_read_b64_tr_b16 v[202:203], v181
    ds_read_b64_tr_b16 v[204:205], v182
    ds_read_b64_tr_b16 v[206:207], v183
    ds_read_b64_tr_b16 v[208:209], v184
    ds_read_b64_tr_b16 v[210:211], v185
    s_bitcmp1_b32 s51, 8
    s_cbranch_scc1 L_r_562
L_rr_563:
    s_waitcnt lgkmcnt(6)
    v_mfma_f32_16x16x32_bf16 v[8:11], v[220:223], v[252:255], v[8:11]
    v_mfma_f32_16x16x32_bf16 v[8:11], v[224:227], v[252:255], v[8:11]
    v_mfma_f32_16x16x32_bf16 v[8:11], v[228:231], v[252:255], v[8:11]
    s_bitcmp1_b32 s51, 7
    s_cbranch_scc1 L_m_564
L_mr_565:
    s_cmp_eq_u32 s52, 7
    s_cbranch_scc1 L_a7_566
    s_nop 5
    v_mul_f32 v8, v8, v31
    v_mul_f32 v9, v9, v31
    v_mul_f32 v10, v10, v31
    v_mul_f32 v11, v11, v31
    v_cvt_pk_bf16_f32 v26, v8, v9
    v_cvt_pk_bf16_f32 v27, v10, v11
    v_lshlrev_b32 v8, 16, v26
    v_and_b32 v9, 0xffff0000, v26
    v_lshlrev_b32 v10, 16, v27
    v_and_b32 v11, 0xffff0000, v27
    v_mul_f32 v8, v8, v31
    v_mul_f32 v9, v9, v31
    v_mul_f32 v10, v10, v31
    v_mul_f32 v11, v11, v31
    v_cvt_pk_bf16_f32 v18, v8, v9
    v_cvt_pk_bf16_f32 v19, v10, v11
    s_waitcnt vmcnt(0)
    s_sub_u32 s58, 0, s42
    s_mov_b64 exec, 255
    v_lshl_add_u64 v[40:41], v[94:95], 0, s[58:59]
    v_cmp_le_u64 vcc, 64, v[40:41]
    s_cbranch_vccnz L_pl_568
L_pd_569:
    s_mov_b64 exec, -1
    s_cmp_lg_u32 s50, 0
    s_cbranch_scc1 L_xs_570
    buffer_store_dwordx4 v[16:19], v33, s[4:7], s53 offen
L_xe_571:
L_a7r_567:
    ds_read_b64_tr_b16 v[220:221], v190
    ds_read_b64_tr_b16 v[222:223], v191
    ds_read_b64_tr_b16 v[224:225], v192
    ds_read_b64_tr_b16 v[226:227], v193
    ds_read_b64_tr_b16 v[228:229], v194
    ds_read_b64_tr_b16 v[230:231], v195
    s_bitcmp1_b32 s51, 9
    s_cbranch_scc1 L_r_572
L_rr_573:
    s_waitcnt lgkmcnt(6)
    v_mfma_f32_16x16x32_bf16 v[12:15], v[200:203], v[240:243], 0
    v_mfma_f32_16x16x32_bf16 v[12:15], v[204:207], v[240:243], v[12:15]
    v_mfma_f32_16x16x32_bf16 v[12:15], v[208:211], v[240:243], v[12:15]
    s_bitcmp1_b32 s51, 8
    s_cbranch_scc1 L_m_574
L_mr_575:
    s_cmp_eq_u32 s52, 7
    s_cbranch_scc1 L_a7_576
    v_mov_b32 v22, s55
    s_waitcnt vmcnt(0)
    s_cmp_lg_u32 s50, 0
    s_cbranch_scc1 L_xs_578
    s_mov_b64 exec, 1
    buffer_store_dwordx2 v[22:23], v38, s[4:7], 0 offen
    s_mov_b64 exec, -1
L_xe_579:
    s_cmp_lg_u32 s87, 0
    s_cbranch_scc1 L_tc_580
L_tcr_581:
L_a7r_577:
    s_waitcnt lgkmcnt(0)
    v_mfma_f32_16x16x32_bf16 v[12:15], v[220:223], v[244:247], v[12:15]
    v_mfma_f32_16x16x32_bf16 v[12:15], v[224:227], v[244:247], v[12:15]
    v_mfma_f32_16x16x32_bf16 v[12:15], v[228:231], v[244:247], v[12:15]
    s_bitcmp1_b32 s51, 9
    s_cbranch_scc1 L_m_585
L_mr_586:
L_gath_done:
    s_cmp_eq_u32 s52, 7
    s_cbranch_scc1 L_gath7_done
    s_mov_b64 exec, 0xff
    buffer_load_dwordx2 v[94:95], v37, s[4:7], 0 offen sc1
    s_mov_b64 exec, -1
    s_nop 2
    v_mul_f32 v12, v12, v32
    v_mul_f32 v13, v13, v32
    v_mul_f32 v14, v14, v32
    v_mul_f32 v15, v15, v32
    v_cvt_pk_bf16_f32 v28, v12, v13
    v_cvt_pk_bf16_f32 v29, v14, v15
    v_lshlrev_b32 v12, 16, v28
    v_and_b32 v13, 0xffff0000, v28
    v_lshlrev_b32 v14, 16, v29
    v_and_b32 v15, 0xffff0000, v29
    v_mul_f32 v12, v12, v32
    v_mul_f32 v13, v13, v32
    v_mul_f32 v14, v14, v32
    v_mul_f32 v15, v15, v32
    v_cvt_pk_bf16_f32 v20, v12, v13
    v_cvt_pk_bf16_f32 v21, v14, v15
    s_cmp_lg_u32 s50, 0
    s_cbranch_scc1 L_xs_587
    buffer_store_dwordx2 v[20:21], v34, s[4:7], s53 offen
L_xe_588:
    s_barrier
    v_mov_b32 v22, s56
    s_waitcnt vmcnt(0)
    s_cmp_lg_u32 s50, 0
    s_cbranch_scc1 L_xs_589
    s_mov_b64 exec, 1
    buffer_store_dwordx2 v[22:23], v38, s[4:7], 0 offen
    s_mov_b64 exec, -1
L_xe_590:
    s_sub_u32 s58, 0, s55
    s_mov_b64 exec, 255
    v_lshl_add_u64 v[40:41], v[94:95], 0, s[58:59]
    v_cmp_le_u64 vcc, 64, v[40:41]
    s_cbranch_vccnz L_pl_591
L_pd_592:
    s_mov_b64 exec, -1
    s_add_u32 m0, s100, s80
    s_add_u32 s97, s53, s80
    buffer_load_dwordx4 v35, s[4:7], s97 offen sc1 lds
    s_add_u32 m0, s100, s81
    s_add_u32 s97, s53, s81
    buffer_load_dwordx4 v35, s[4:7], s97 offen sc1 lds
    s_add_u32 m0, s100, s82
    s_add_u32 s97, s53, s82
    buffer_load_dwordx4 v35, s[4:7], s97 offen sc1 lds
    s_cmp_lt_u32 s44, 4
    s_cselect_b32 exec_lo, 0xffff, 0
    s_mov_b32 exec_hi, 0
    buffer_load_dwordx2 v[94:95], v39, s[4:7], 0 offen sc1
    s_mov_b64 exec, -1
    s_add_u32 m0, s100, s83
    s_add_u32 s97, s53, s83
    buffer_load_dwordx4 v35, s[4:7], s97 offen sc1 lds
    s_add_u32 m0, s100, s84
    s_add_u32 s97, s53, s84
    buffer_load_dwordx4 v35, s[4:7], s97 offen sc1 lds
    s_add_u32 m0, s100, s85
    s_add_u32 s97, s53, s85
    buffer_load_dwordx4 v35, s[4:7], s97 offen sc1 lds
    s_add_u32 m0, s100, s86
    s_add_u32 s97, s53, s86
    buffer_load_dwordx4 v35, s[4:7], s97 offen sc1 lds
    ds_write_b128 v3, v[16:19]
    s_cmp_ge_u32 s44, 4
    s_cbranch_scc1 L_nob
    s_waitcnt vmcnt(4)
    s_sub_u32 s58, 0, s56
    s_mov_b64 exec, 65535
    v_lshl_add_u64 v[40:41], v[94:95], 0, s[58:59]
    v_cmp_le_u64 vcc, 64, v[40:41]
    s_cbranch_vccnz L_pl_593
L_pd_594:
    s_mov_b64 exec, -1
    s_mov_b32 m0, s101
    s_nop 0
    buffer_load_dwordx4 v36, s[4:7], s53 offen offset:0 sc1 lds
    buffer_load_dwordx4 v36, s[4:7], s53 offen offset:1024 sc1 lds
    buffer_load_dwordx4 v36, s[4:7], s53 offen offset:2048 sc1 lds
    buffer_load_dwordx4 v36, s[4:7], s53 offen offset:3072 sc1 lds
L_nob:
    s_cmp_lt_u32 s41, 18
    s_cbranch_scc1 L_prepW
L_prepB_back:
    s_waitcnt vmcnt(0) lgkmcnt(0)
L_bar2:
    s_barrier
    s_add_u32 s52, s52, 1
    s_branch L_hop
L_slow:
    v_mov_b32 v4, 0
    v_mov_b32 v5, 0
    v_mov_b32 v6, 0
    v_mov_b32 v7, 0
    v_mov_b32 v8, 0
    v_mov_b32 v9, 0
    v_mov_b32 v10, 0
    v_mov_b32 v11, 0
    v_mov_b32 v12, 0
    v_mov_b32 v13, 0
    v_mov_b32 v14, 0
    v_mov_b32 v15, 0
    s_lshl_b32 s96, s49, 7
    v_lshl_add_u32 v200, v1, 1, s96
    v_add_u32 v201, 1, v200
    s_lshl_b32 s96, s49, 5
    s_add_u32 s96, s96, 8192
    v_add_u32 v202, s96, v96
    v_lshlrev_b32 v216, 2, v1
    s_mov_b32 s92, 0
    s_add_u32 s94, s49, 256
L_slow_e:
    buffer_load_dword v203, v216, s[12:15], s92 offen
    buffer_load_dword v204, v216, s[8:11], s92 offen
    s_waitcnt vmcnt(0)
    v_lshrrev_b32 v205, 7, v203
    v_lshrrev_b32 v206, 5, v203
    v_cmp_eq_u32 s[96:97], s49, v205
    v_cmp_eq_u32 vcc, s94, v206
    s_nop 0
    s_or_b64 s[96:97], s[96:97], vcc
    s_nop 2
L_slow_b:
    s_cmp_eq_u64 s[96:97], 0
    s_cbranch_scc1 L_slow_n
    s_ff1_i32_b64 s95, s[96:97]
    s_bitset0_b64 s[96:97], s95
    v_readlane_b32 s98, v203, s95
    v_readlane_b32 s99, v204, s95
    s_nop 0
    s_lshl_b32 s99, s99, 3
    s_add_u32 s99, s99, 81920
    v_mov_b32 v214, s99
    ds_read_b64 v[212:213], v214
    s_waitcnt lgkmcnt(0)
    v_lshlrev_b32 v208, 16, v212
    v_and_b32 v209, 0xffff0000, v212
    v_lshlrev_b32 v210, 16, v213
    v_and_b32 v211, 0xffff0000, v213
    v_cmp_eq_u32 vcc, s98, v200
    s_nop 0
    s_mov_b64 exec, vcc
    v_add_f32 v4, v4, v208
    v_add_f32 v5, v5, v209
    v_add_f32 v6, v6, v210
    v_add_f32 v7, v7, v211
    s_mov_b64 exec, -1
    v_cmp_eq_u32 vcc, s98, v201
    s_nop 0
    s_mov_b64 exec, vcc
    v_add_f32 v8, v8, v208
    v_add_f32 v9, v9, v209
    v_add_f32 v10, v10, v210
    v_add_f32 v11, v11, v211
    s_mov_b64 exec, -1
    v_cmp_eq_u32 vcc, s98, v202
    s_nop 0
    s_mov_b64 exec, vcc
    v_add_f32 v12, v12, v208
    v_add_f32 v13, v13, v209
    v_add_f32 v14, v14, v210
    v_add_f32 v15, v15, v211
    s_mov_b64 exec, -1
    s_branch L_slow_b
L_slow_n:
    s_add_u32 s92, s92, 256
    s_cmp_lt_u32 s92, 640000
    s_cbranch_scc1 L_slow_e
    s_cmp_eq_u32 s52, 7
    s_cbranch_scc1 L_slow7
    v_mul_f32 v4, v4, v30
    v_mul_f32 v5, v5, v30
    v_mul_f32 v6, v6, v30
    v_mul_f32 v7, v7, v30
    v_cvt_pk_bf16_f32 v24, v4, v5
    v_cvt_pk_bf16_f32 v25, v6, v7
    v_lshlrev_b32 v4, 16, v24
    v_and_b32 v5, 0xffff0000, v24
    v_lshlrev_b32 v6, 16, v25
    v_and_b32 v7, 0xffff0000, v25
    v_mul_f32 v4, v4, v30
    v_mul_f32 v5, v5, v30
    v_mul_f32 v6, v6, v30
    v_mul_f32 v7, v7, v30
    v_cvt_pk_bf16_f32 v16, v4, v5
    v_cvt_pk_bf16_f32 v17, v6, v7
    v_mul_f32 v8, v8, v31
    v_mul_f32 v9, v9, v31
    v_mul_f32 v10, v10, v31
    v_mul_f32 v11, v11, v31
    v_cvt_pk_bf16_f32 v26, v8, v9
    v_cvt_pk_bf16_f32 v27, v10, v11
    v_lshlrev_b32 v8, 16, v26
    v_and_b32 v9, 0xffff0000, v26
    v_lshlrev_b32 v10, 16, v27
    v_and_b32 v11, 0xffff0000, v27
    v_mul_f32 v8, v8, v31
    v_mul_f32 v9, v9, v31
    v_mul_f32 v10, v10, v31
    v_mul_f32 v11, v11, v31
    v_cvt_pk_bf16_f32 v18, v8, v9
    v_cvt_pk_bf16_f32 v19, v10, v11
    s_sub_u32 s58, 0, s42
    s_mov_b64 exec, 255
L_pl_595:
    buffer_load_dwordx2 v[94:95], v37, s[4:7], 0 offen sc1
    s_add_u32 s57, s57, 1
    s_cmp_gt_u32 s57, 4194304
    s_cbranch_scc1 L_end
    s_waitcnt vmcnt(0)
    v_lshl_add_u64 v[40:41], v[94:95], 0, s[58:59]
    v_cmp_le_u64 vcc, 64, v[40:41]
    s_cbranch_vccnz L_pl_595
    s_mov_b64 exec, -1
    s_cmp_lg_u32 s50, 0
    s_cbranch_scc1 L_xs_597
    buffer_store_dwordx4 v[16:19], v33, s[4:7], s53 offen
L_xe_598:
    v_mov_b32 v22, s55
    s_waitcnt vmcnt(0)
    s_cmp_lg_u32 s50, 0
    s_cbranch_scc1 L_xs_599
    s_mov_b64 exec, 1
    buffer_store_dwordx2 v[22:23], v38, s[4:7], 0 offen
    s_mov_b64 exec, -1
L_xe_600:
    s_cmp_lg_u32 s87, 0
    s_cbranch_scc1 L_tc_601
L_tcr_602:
    s_branch L_gath_done
L_slow7:
    v_mul_f32 v4, v4, v30
    v_mul_f32 v5, v5, v30
    v_mul_f32 v6, v6, v30
    v_mul_f32 v7, v7, v30
    v_cvt_pk_bf16_f32 v24, v4, v5
    v_cvt_pk_bf16_f32 v25, v6, v7
    v_mul_f32 v8, v8, v31
    v_mul_f32 v9, v9, v31
    v_mul_f32 v10, v10, v31
    v_mul_f32 v11, v11, v31
    v_cvt_pk_bf16_f32 v26, v8, v9
    v_cvt_pk_bf16_f32 v27, v10, v11
    s_lshl_b32 s93, s44, 2
    v_bfe_u32 v42, v1, 3, 2
    v_add_u32 v42, s93, v42
    v_lshlrev_b32 v47, 15, v42
    v_mul_u32_u24 v49, 320, v42
    v_and_b32 v42, 7, v1
    v_lshl_add_u32 v47, v42, 4, v47
    v_lshl_add_u32 v49, v42, 3, v49
    v_add_u32 v49, 72048, v49
    s_lshl_b32 s82, s2, 7
    s_add_u32 s82, s82, 29360128
    s_lshl_b32 s92, s48, 15
    s_lshl_b32 s96, s49, 9
    s_add_u32 s92, s92, s96
    v_lshl_add_u32 v34, v96, 4, s92
    v_mov_b32 v66, v23
    v_mov_b32 v67, v23
    s_lshl_b32 s96, s2, 8
    s_lshr_b32 s97, s96, 2
    s_add_u32 s97, s97, 65280
    s_mov_b32 s92, 81920
    v_mul_u32_u24 v41, 3277, v1
    v_lshrrev_b32 v41, 16, v41
    v_mul_u32_u24 v42, 20, v41
    v_sub_u32 v42, v1, v42
    v_add_u32 v41, s93, v41
    v_mul_lo_u32 v41, v41, s92
    v_mov_b32 v40, s97
    v_mov_b32 v43, s96
    v_cmp_gt_u32 vcc, 16, v42
    s_nop 1
    v_cndmask_b32 v50, v40, v43, vcc
    s_mov_b64 s[80:81], vcc
    v_lshl_add_u32 v50, v42, 4, v50
    v_add_u32 v50, v50, v41
    v_cmp_gt_u32 vcc, 12, v1
    s_nop 1
    v_cndmask_b32 v51, v40, v43, vcc
    v_lshl_add_u32 v51, v1, 4, v51
    s_add_u32 s93, s93, 3
    s_mul_i32 s93, s93, 81920
    s_add_u32 s93, s93, 64
    v_add_u32 v51, s93, v51
    buffer_store_dwordx4 v[24:27], v33, s[4:7], s54 offen sc1
    s_branch L_gath7_done
    s_nop 0
L_prepA:
    s_cmp_ge_u32 s41, 8
    s_cselect_b32 s32, s64, s60
    s_cselect_b32 s33, s65, s61
    s_cselect_b32 s36, s66, s62
    s_cselect_b32 s37, s67, s63
    s_mov_b32 s34, 32768
    s_mov_b32 s35, 0x20000
    s_mov_b32 s38, 32768
    s_mov_b32 s39, 0x20000
    s_mov_b32 s24, s68
    s_mov_b32 s25, s69
    s_mov_b32 s26, 256
    s_mov_b32 s27, 0x20000
    v_and_b32 v81, 12, v1
    v_lshlrev_b32 v81, 9, v81
    v_and_b32 v80, 3, v1
    v_lshl_add_u32 v80, v80, 8, v81
    v_lshrrev_b32 v81, 4, v1
    v_lshl_add_u32 v80, v81, 4, v80
    s_cmp_eq_u32 s41, 16
    s_cbranch_scc1 L_prepA_lin
    s_lshr_b32 s72, s44, 1
    s_lshl_b32 s75, s72, 6
    s_lshl_b32 s72, s72, 13
    s_and_b32 s73, s44, 1
    s_lshl_b32 s74, s73, 3
    s_add_u32 s75, s75, s74
    s_lshl_b32 s73, s73, 10
    s_add_u32 s72, s72, s73
    s_bfe_u32 s73, s41, 0x20001
    s_lshl_b32 s73, s73, 5
    s_and_b32 s74, s41, 1
    s_lshl_b32 s74, s74, 2
    s_add_u32 s73, s73, s74
    s_lshl_b32 s74, s73, 8
    s_add_u32 s74, s74, s75
    s_lshl_b32 s73, s73, 1
    s_add_u32 s73, s73, s72
    s_cmp_ge_u32 s41, 8
    s_cselect_b32 s73, s73, s74
    buffer_load_dwordx2 v[62:63], v80, s[36:39], s73 offen
    buffer_load_dwordx4 v[46:49], v80, s[32:35], s72 offen offset:0
    buffer_load_dwordx4 v[50:53], v80, s[32:35], s72 offen offset:64
    buffer_load_dwordx4 v[54:57], v80, s[32:35], s72 offen offset:128
    buffer_load_dwordx4 v[58:61], v80, s[32:35], s72 offen offset:192
    s_branch L_hop1
L_prepA_lin:
    v_and_b32 v81, 48, v1
    s_waitcnt vmcnt(3)
    buffer_load_dwordx4 v[46:49], v81, s[24:27], 0 offen offset:0
    s_waitcnt vmcnt(3)
    buffer_load_dwordx4 v[50:53], v81, s[24:27], 0 offen offset:64
    s_waitcnt vmcnt(3)
    buffer_load_dwordx4 v[54:57], v81, s[24:27], 0 offen offset:128
    s_waitcnt vmcnt(3)
    buffer_load_dwordx4 v[58:61], v81, s[24:27], 0 offen offset:192
    s_branch L_hop1
L_prepB:
    s_cmp_eq_u32 s41, 16
    s_cbranch_scc1 L_prepB_lin
    s_cmp_lt_u32 s41, 8
    s_cbranch_scc1 L_prepB_m
    v_and_b32 v81, 15, v1
    v_lshrrev_b32 v82, 4, v1
    v_lshlrev_b32 v82, 2, v82
    v_sub_u32 v81, v81, v82
    v_mov_b32 v82, 0x3f80
    v_cmp_eq_u32 vcc, 0, v81
    s_nop 1
    v_cndmask_b32 v78, 0, v82, vcc
    v_cmp_eq_u32 vcc, 2, v81
    s_nop 1
    v_cndmask_b32 v79, 0, v82, vcc
    v_mov_b32 v82, 0x3f800000
    v_cmp_eq_u32 vcc, 1, v81
    s_nop 1
    v_cndmask_b32 v78, v78, v82, vcc
    v_cmp_eq_u32 vcc, 3, v81
    s_nop 1
    v_cndmask_b32 v79, v79, v82, vcc
    s_nop 1
    v_mfma_f32_16x16x16_bf16 v[200:203], v[62:63], v[78:79], 0
    s_nop 7
    v_cvt_pk_bf16_f32 v62, v200, v201
    v_cvt_pk_bf16_f32 v63, v202, v203
    s_nop 1
L_prepB_m:
    s_lshr_b32 s72, s44, 1
    s_lshl_b32 s72, s72, 10
    s_and_b32 s73, s44, 1
    s_lshl_b32 s73, s73, 3
    s_add_u32 s72, s72, s73
    s_add_u32 s72, s72, 72704
    v_lshl_add_u32 v80, v1, 4, s72
    ds_write_b64 v80, v[62:63]
    s_branch L_prepB_back
L_prepB2:
    v_lshlrev_b32 v80, 4, v1
    v_add_u32 v80, 72704, v80
    ds_read_b128 v[62:65], v80 offset:0
    ds_read_b128 v[66:69], v80 offset:1024
    ds_read_b128 v[70:73], v80 offset:2048
    ds_read_b128 v[74:77], v80 offset:3072
    s_waitcnt lgkmcnt(3)
    v_mfma_f32_16x16x32_bf16 v[84:87], v[46:49], v[62:65], 0
    s_waitcnt lgkmcnt(2)
    v_mfma_f32_16x16x32_bf16 v[84:87], v[50:53], v[66:69], v[84:87]
    s_waitcnt lgkmcnt(1)
    v_mfma_f32_16x16x32_bf16 v[84:87], v[54:57], v[70:73], v[84:87]
    s_waitcnt lgkmcnt(0)
    v_mfma_f32_16x16x32_bf16 v[84:87], v[58:61], v[74:77], v[84:87]
    v_lshlrev_b32 v80, 5, v1
    s_lshl_b32 s72, s44, 2
    s_add_u32 s72, s72, 72192
    v_add_u32 v80, s72, v80
    s_nop 3
    v_add_f32 v81, v84, v85
    v_add_f32 v82, v86, v87
    v_add_f32 v81, v81, v82
    v_mov_b32 v82, v81
    s_nop 1
    v_permlane16_swap_b32 v81, v82
    v_add_f32 v81, v81, v82
    v_mov_b32 v82, v81
    s_nop 1
    v_permlane32_swap_b32 v81, v82
    v_add_f32 v81, v81, v82
    s_mov_b64 exec, 0xffff
    ds_write_b32 v80, v81
    s_mov_b64 exec, -1
    s_branch L_prepB_back
L_prepB_lin:
    s_cmp_lg_u32 s44, 0
    s_cbranch_scc1 L_prepB_back
    v_and_b32 v82, 3, v1
    v_cmp_eq_u32 s[72:73], 1, v82
    v_cmp_eq_u32 vcc, 0, v82
    v_mov_b32 v82, 0x3f803f80
    v_mov_b32 v62, 0x3f803f80
    v_mov_b32 v63, 0x3f803f80
    v_mov_b32 v64, 0x3f803f80
    v_mov_b32 v65, 0x3f803f80
    v_cndmask_b32 v82, 0, v82, vcc
    v_cndmask_b32 v46, v82, v46, s[72:73]
    v_cndmask_b32 v47, v82, v47, s[72:73]
    v_cndmask_b32 v48, v82, v48, s[72:73]
    v_cndmask_b32 v49, v82, v49, s[72:73]
    v_cndmask_b32 v50, v82, v50, s[72:73]
    v_cndmask_b32 v51, v82, v51, s[72:73]
    v_cndmask_b32 v52, v82, v52, s[72:73]
    v_cndmask_b32 v53, v82, v53, s[72:73]
    v_cndmask_b32 v54, v82, v54, s[72:73]
    v_cndmask_b32 v55, v82, v55, s[72:73]
    v_cndmask_b32 v56, v82, v56, s[72:73]
    v_cndmask_b32 v57, v82, v57, s[72:73]
    v_cndmask_b32 v58, v82, v58, s[72:73]
    v_cndmask_b32 v59, v82, v59, s[72:73]
    v_cndmask_b32 v60, v82, v60, s[72:73]
    v_cndmask_b32 v61, v82, v61, s[72:73]
    v_mfma_f32_16x16x32_bf16 v[200:203], v[46:49], v[62:65], 0
    v_mfma_f32_16x16x32_bf16 v[200:203], v[50:53], v[62:65], v[200:203]
    v_mfma_f32_16x16x32_bf16 v[200:203], v[54:57], v[62:65], v[200:203]
    v_mfma_f32_16x16x32_bf16 v[200:203], v[58:61], v[62:65], v[200:203]
    v_lshlrev_b32 v81, 4, v1
    s_mov_b32 s74, 327680
    s_waitcnt vmcnt(0)
    buffer_store_dwordx4 v[46:49], v81, s[4:7], s74 offen offset:0 sc1
    buffer_store_dwordx4 v[50:53], v81, s[4:7], s74 offen offset:1024 sc1
    buffer_store_dwordx4 v[54:57], v81, s[4:7], s74 offen offset:2048 sc1
    buffer_store_dwordx4 v[58:61], v81, s[4:7], s74 offen offset:3072 sc1
    v_lshlrev_b32 v81, 2, v1
    s_mov_b32 s74, 331776
    buffer_store_dword v201, v81, s[4:7], s74 offen sc1
    s_branch L_prepS
L_prepS:
    s_waitcnt lgkmcnt(0)
    s_branch L_bar2
L_prepC:
    v_and_b32 v80, 15, v1
    v_lshlrev_b32 v80, 5, v80
    v_add_u32 v80, 72192, v80
    ds_read_b128 v[46:49], v80
    ds_read_b128 v[50:53], v80 offset:16
    s_lshr_b32 s72, s44, 1
    s_lshl_b32 s72, s72, 10
    s_and_b32 s73, s44, 1
    s_lshl_b32 s73, s73, 3
    s_add_u32 s72, s72, s73
    s_add_u32 s72, s72, 72704
    v_lshl_add_u32 v80, v1, 4, s72
    s_waitcnt lgkmcnt(1)
    v_add_f32 v81, v46, v47
    v_add_f32 v82, v48, v49
    s_waitcnt lgkmcnt(0)
    v_add_f32 v81, v81, v50
    v_add_f32 v82, v82, v51
    v_add_f32 v81, v81, v52
    v_add_f32 v82, v82, v53
    v_add_f32 v81, v81, v82
    v_mul_f32 v81, 0x3c000000, v81
    v_sub_f32 v84, v84, v81
    v_sub_f32 v85, v85, v81
    v_sub_f32 v86, v86, v81
    v_sub_f32 v87, v87, v81
    v_cvt_pk_bf16_f32 v62, v84, v85
    v_cvt_pk_bf16_f32 v63, v86, v87
    ds_write_b64 v80, v[62:63]
    s_branch L_prepB_back
L_prepD:
    s_cmp_ge_u32 s44, 4
    s_cbranch_scc1 L_prepDr
    s_lshl_b32 s72, s44, 10
    s_add_u32 s73, s72, 72704
    v_lshl_add_u32 v80, v1, 4, s73
    ds_read_b128 v[62:65], v80
    s_lshl_b32 s73, s41, 12
    s_add_u32 s72, s72, s73
    s_add_u32 s72, s72, 262144
    v_lshlrev_b32 v80, 4, v1
    s_waitcnt lgkmcnt(0)
    buffer_store_dwordx4 v[62:65], v80, s[4:7], s72 offen sc1
    s_branch L_prepDr
L_rare:
v_cmp_gt_u32 vcc, s94, v54
s_cbranch_vccz L_rs_460
s_mov_b64 exec, vcc
ds_add_rtn_u32 v85, v72, v71 offset:39300
s_waitcnt lgkmcnt(0)
ds_write_b32 v85, v54
s_mov_b64 exec, -1
L_rs_460:
v_cmp_gt_u32 vcc, s94, v55
s_cbranch_vccz L_rs_461
s_mov_b64 exec, vcc
ds_add_rtn_u32 v85, v72, v71 offset:39300
s_waitcnt lgkmcnt(0)
ds_write_b32 v85, v55
s_mov_b64 exec, -1
L_rs_461:
v_cmp_gt_u32 vcc, s94, v56
s_cbranch_vccz L_rs_462
s_mov_b64 exec, vcc
ds_add_rtn_u32 v85, v72, v71 offset:39300
s_waitcnt lgkmcnt(0)
ds_write_b32 v85, v56
s_mov_b64 exec, -1
L_rs_462:
v_cmp_gt_u32 vcc, s94, v57
s_cbranch_vccz L_rs_463
s_mov_b64 exec, vcc
ds_add_rtn_u32 v85, v72, v71 offset:39300
s_waitcnt lgkmcnt(0)
ds_write_b32 v85, v57
s_mov_b64 exec, -1
L_rs_463:
v_cmp_gt_u32 vcc, s94, v58
s_cbranch_vccz L_rs_464
s_mov_b64 exec, vcc
ds_add_rtn_u32 v85, v72, v71 offset:39300
s_waitcnt lgkmcnt(0)
ds_write_b32 v85, v58
s_mov_b64 exec, -1
L_rs_464:
v_cmp_gt_u32 vcc, s94, v59
s_cbranch_vccz L_rs_465
s_mov_b64 exec, vcc
ds_add_rtn_u32 v85, v72, v71 offset:39300
s_waitcnt lgkmcnt(0)
ds_write_b32 v85, v59
s_mov_b64 exec, -1
L_rs_465:
v_cmp_gt_u32 vcc, s94, v60
s_cbranch_vccz L_rs_466
s_mov_b64 exec, vcc
ds_add_rtn_u32 v85, v72, v71 offset:39300
s_waitcnt lgkmcnt(0)
ds_write_b32 v85, v60
s_mov_b64 exec, -1
L_rs_466:
v_cmp_gt_u32 vcc, s94, v61
s_cbranch_vccz L_rs_467
s_mov_b64 exec, vcc
ds_add_rtn_u32 v85, v72, v71 offset:39300
s_waitcnt lgkmcnt(0)
ds_write_b32 v85, v61
s_mov_b64 exec, -1
L_rs_467:
s_waitcnt lgkmcnt(0)
s_branch L_rared
L_ov_468:
v_mov_b32 v82, 0x100000
ds_or_b32 v72, v82 offset:39296
s_waitcnt lgkmcnt(0)
s_branch L_ovr_469
L_ov_470:
v_mov_b32 v82, 0x100000
ds_or_b32 v72, v82 offset:39296
s_waitcnt lgkmcnt(0)
s_branch L_ovr_471
L_pl_474:
buffer_load_dwordx2 v[94:95], v39, s[4:7], 0 offen sc1
s_add_u32 s57, s57, 1
s_cmp_gt_u32 s57, 4194304
s_cbranch_scc1 L_end
s_waitcnt vmcnt(0)
v_lshl_add_u64 v[40:41], v[94:95], 0, s[58:59]
v_cmp_le_u64 vcc, 64, v[40:41]
s_cbranch_vccz L_pn_476
s_sleep 4
s_branch L_pl_474
L_pn_476:
s_branch L_pd_475
L_xs_477:
s_nop 4
s_mov_b64 exec, 1
buffer_store_dwordx2 v[22:23], v38, s[4:7], 0 offen sc1
s_mov_b64 exec, -1
s_nop 1
s_branch L_xe_478
L_r_480:
ds_read_b64_tr_b16 v[212:213], v106
ds_read_b64_tr_b16 v[214:215], v107
s_bitcmp1_b32 s51, 10
s_cbranch_scc0 L_rr_481
ds_read_b64_tr_b16 v[216:217], v108
ds_read_b64_tr_b16 v[218:219], v109
s_branch L_rr_481
L_r_482:
ds_read_b64_tr_b16 v[232:233], v116
ds_read_b64_tr_b16 v[234:235], v117
s_bitcmp1_b32 s51, 11
s_cbranch_scc0 L_rr_483
ds_read_b64_tr_b16 v[236:237], v118
ds_read_b64_tr_b16 v[238:239], v119
s_branch L_rr_483
L_m_484:
v_mfma_f32_16x16x32_bf16 v[4:7], v[212:215], v[240:243], v[4:7]
s_bitcmp1_b32 s51, 10
s_cbranch_scc0 L_mr_485
v_mfma_f32_16x16x32_bf16 v[4:7], v[216:219], v[240:243], v[4:7]
s_branch L_mr_485
L_r_486:
ds_read_b64_tr_b16 v[212:213], v126
ds_read_b64_tr_b16 v[214:215], v127
s_bitcmp1_b32 s51, 12
s_cbranch_scc0 L_rr_487
ds_read_b64_tr_b16 v[216:217], v128
ds_read_b64_tr_b16 v[218:219], v129
s_branch L_rr_487
L_m_488:
v_mfma_f32_16x16x32_bf16 v[4:7], v[232:235], v[244:247], v[4:7]
s_bitcmp1_b32 s51, 11
s_cbranch_scc0 L_mr_489
v_mfma_f32_16x16x32_bf16 v[4:7], v[236:239], v[244:247], v[4:7]
s_branch L_mr_489
L_r_490:
ds_read_b64_tr_b16 v[232:233], v136
ds_read_b64_tr_b16 v[234:235], v137
s_bitcmp1_b32 s51, 13
s_cbranch_scc0 L_rr_491
ds_read_b64_tr_b16 v[236:237], v138
ds_read_b64_tr_b16 v[238:239], v139
s_branch L_rr_491
L_m_492:
v_mfma_f32_16x16x32_bf16 v[4:7], v[212:215], v[248:251], v[4:7]
s_bitcmp1_b32 s51, 12
s_cbranch_scc0 L_mr_493
v_mfma_f32_16x16x32_bf16 v[4:7], v[216:219], v[248:251], v[4:7]
s_branch L_mr_493
L_r_494:
ds_read_b64_tr_b16 v[212:213], v146
ds_read_b64_tr_b16 v[214:215], v147
s_bitcmp1_b32 s51, 14
s_cbranch_scc0 L_rr_495
ds_read_b64_tr_b16 v[216:217], v148
ds_read_b64_tr_b16 v[218:219], v149
s_branch L_rr_495
L_m_496:
v_mfma_f32_16x16x32_bf16 v[4:7], v[232:235], v[252:255], v[4:7]
s_bitcmp1_b32 s51, 13
s_cbranch_scc0 L_mr_497
v_mfma_f32_16x16x32_bf16 v[4:7], v[236:239], v[252:255], v[4:7]
s_branch L_mr_497
L_r_498:
ds_read_b64_tr_b16 v[232:233], v156
ds_read_b64_tr_b16 v[234:235], v157
s_bitcmp1_b32 s51, 15
s_cbranch_scc0 L_rr_499
ds_read_b64_tr_b16 v[236:237], v158
ds_read_b64_tr_b16 v[238:239], v159
s_branch L_rr_499
L_m_500:
v_mfma_f32_16x16x32_bf16 v[8:11], v[212:215], v[240:243], v[8:11]
s_bitcmp1_b32 s51, 14
s_cbranch_scc0 L_mr_501
v_mfma_f32_16x16x32_bf16 v[8:11], v[216:219], v[240:243], v[8:11]
s_branch L_mr_501
L_r_502:
ds_read_b64_tr_b16 v[212:213], v166
ds_read_b64_tr_b16 v[214:215], v167
s_bitcmp1_b32 s51, 16
s_cbranch_scc0 L_rr_503
ds_read_b64_tr_b16 v[216:217], v168
ds_read_b64_tr_b16 v[218:219], v169
s_branch L_rr_503
L_m_504:
v_mfma_f32_16x16x32_bf16 v[8:11], v[232:235], v[244:247], v[8:11]
s_bitcmp1_b32 s51, 15
s_cbranch_scc0 L_mr_505
v_mfma_f32_16x16x32_bf16 v[8:11], v[236:239], v[244:247], v[8:11]
s_branch L_mr_505
L_r_506:
ds_read_b64_tr_b16 v[232:233], v176
ds_read_b64_tr_b16 v[234:235], v177
s_bitcmp1_b32 s51, 17
s_cbranch_scc0 L_rr_507
ds_read_b64_tr_b16 v[236:237], v178
ds_read_b64_tr_b16 v[238:239], v179
s_branch L_rr_507
L_m_508:
v_mfma_f32_16x16x32_bf16 v[8:11], v[212:215], v[248:251], v[8:11]
s_bitcmp1_b32 s51, 16
s_cbranch_scc0 L_mr_509
v_mfma_f32_16x16x32_bf16 v[8:11], v[216:219], v[248:251], v[8:11]
s_branch L_mr_509
L_r_510:
ds_read_b64_tr_b16 v[212:213], v186
ds_read_b64_tr_b16 v[214:215], v187
s_bitcmp1_b32 s51, 18
s_cbranch_scc0 L_rr_511
ds_read_b64_tr_b16 v[216:217], v188
ds_read_b64_tr_b16 v[218:219], v189
s_branch L_rr_511
L_m_512:
v_mfma_f32_16x16x32_bf16 v[8:11], v[232:235], v[252:255], v[8:11]
s_bitcmp1_b32 s51, 17
s_cbranch_scc0 L_mr_513
v_mfma_f32_16x16x32_bf16 v[8:11], v[236:239], v[252:255], v[8:11]
s_branch L_mr_513
L_pl_514:
buffer_load_dwordx2 v[94:95], v37, s[4:7], 0 offen sc1
s_add_u32 s57, s57, 1
s_cmp_gt_u32 s57, 4194304
s_cbranch_scc1 L_end
s_waitcnt vmcnt(0)
v_lshl_add_u64 v[40:41], v[94:95], 0, s[58:59]
v_cmp_le_u64 vcc, 64, v[40:41]
s_cbranch_vccnz L_pl_514
s_branch L_pd_515
L_xs_516:
s_nop 4
buffer_store_dwordx4 v[16:19], v33, s[4:7], s53 offen sc1
s_nop 1
s_branch L_xe_517
L_r_518:
ds_read_b64_tr_b16 v[232:233], v196
ds_read_b64_tr_b16 v[234:235], v197
s_bitcmp1_b32 s51, 19
s_cbranch_scc0 L_rr_519
ds_read_b64_tr_b16 v[236:237], v198
ds_read_b64_tr_b16 v[238:239], v199
s_branch L_rr_519
L_m_520:
v_mfma_f32_16x16x32_bf16 v[12:15], v[212:215], v[240:243], v[12:15]
s_bitcmp1_b32 s51, 18
s_cbranch_scc0 L_mr_521
v_mfma_f32_16x16x32_bf16 v[12:15], v[216:219], v[240:243], v[12:15]
s_branch L_mr_521
L_xs_522:
s_nop 4
s_mov_b64 exec, 1
buffer_store_dwordx2 v[22:23], v38, s[4:7], 0 offen sc1
s_mov_b64 exec, -1
s_nop 1
s_branch L_xe_523
L_m_524:
v_mfma_f32_16x16x32_bf16 v[12:15], v[232:235], v[244:247], v[12:15]
s_bitcmp1_b32 s51, 19
s_cbranch_scc0 L_mr_525
v_mfma_f32_16x16x32_bf16 v[12:15], v[236:239], v[244:247], v[12:15]
s_branch L_mr_525
L_xs_526:
s_nop 4
s_mov_b64 exec, 1
buffer_store_dwordx2 v[22:23], v38, s[4:7], 0 offen sc1
s_mov_b64 exec, -1
s_nop 1
s_branch L_xe_527
L_hop2x:
s_cmp_lt_u32 s41, 17
s_cbranch_scc1 L_prepA
s_or_b32 s96, s2, s44
s_cbranch_scc1 L_keeptag
v_mov_b32 v40, 262016
s_mov_b64 exec, 1
buffer_store_dword v23, v40, s[4:7], 0 offen sc1
s_mov_b64 exec, -1
L_keeptag:
s_cmp_lg_u32 s41, 17
s_cbranch_scc1 L_hop1
v_and_b32 v40, 7, v1
v_lshrrev_b32 v41, 3, v1
v_lshlrev_b32 v42, 8, v40
v_lshl_add_u32 v42, v41, 4, v42
s_lshl_b32 s96, s2, 13
s_lshr_b32 s97, s44, 1
s_lshl_b32 s92, s97, 11
s_and_b32 s94, s44, 1
s_lshl_b32 s95, s94, 7
s_add_u32 s92, s92, s95
s_add_u32 s92, s92, s96
buffer_load_dwordx4 v[46:49], v42, s[16:19], s92 offen
s_lshr_b32 s96, s96, 2
s_add_u32 s96, s96, s95
s_add_u32 s96, s96, 2097152
buffer_load_dwordx4 v[50:53], v42, s[16:19], s96 offen
v_mul_u32_u24 v41, 640, v41
v_lshl_add_u32 v41, v40, 3, v41
s_mul_i32 s94, s94, 5120
v_add_u32 v55, s94, v41
s_lshl_b32 s97, s97, 6
v_add_u32 v54, s97, v55
s_branch L_hop1
L_stg:
s_sub_u32 s95, s52, 4
s_mul_i32 s92, s95, 2621440
s_add_u32 s92, s92, 8388608
s_mul_i32 s93, s95, 10256
s_lshl_b32 s94, s44, 10
s_add_u32 s93, s93, s94
s_mov_b32 m0, s93
s_cmp_ge_u32 s44, 2
buffer_load_dwordx4 v97, s[4:7], s92 offen sc1 lds
s_cbranch_scc1 L_sp_528
s_add_u32 m0, s93, 8192
s_cmp_lg_u32 0, 0
buffer_load_dwordx4 v98, s[4:7], s92 offen sc1 lds
L_sp_528:
s_cmp_lg_u32 s52, 7
s_cbranch_scc1 L_stgr
s_lshl_b32 s92, s46, 3
s_add_u32 s92, s92, s44
s_mul_i32 s92, s92, 288
s_add_u32 s92, s92, 262144
v_lshlrev_b32 v40, 5, v1
s_mov_b64 exec, 0x1ff
buffer_load_dword v2, v40, s[4:7], s92 offen
s_mov_b64 exec, -1
s_branch L_stgr
L_tpl:
s_cmp_eq_u32 s52, 7
s_cbranch_scc1 L_hop1
s_mov_b32 exec_hi, 0
buffer_load_dwordx2 v[92:93], v39, s[4:7], s40 offen sc1
s_mov_b64 exec, -1
s_branch L_hop1
L_r_530:
ds_read_b64_tr_b16 v[212:213], v106
ds_read_b64_tr_b16 v[214:215], v107
s_bitcmp1_b32 s51, 10
s_cbranch_scc0 L_rr_531
ds_read_b64_tr_b16 v[216:217], v108
ds_read_b64_tr_b16 v[218:219], v109
s_branch L_rr_531
L_r_532:
ds_read_b64_tr_b16 v[232:233], v116
ds_read_b64_tr_b16 v[234:235], v117
s_bitcmp1_b32 s51, 11
s_cbranch_scc0 L_rr_533
ds_read_b64_tr_b16 v[236:237], v118
ds_read_b64_tr_b16 v[238:239], v119
s_branch L_rr_533
L_m_534:
v_mfma_f32_16x16x32_bf16 v[4:7], v[212:215], v[240:243], v[4:7]
s_bitcmp1_b32 s51, 10
s_cbranch_scc0 L_mr_535
v_mfma_f32_16x16x32_bf16 v[4:7], v[216:219], v[240:243], v[4:7]
s_branch L_mr_535
L_r_536:
ds_read_b64_tr_b16 v[212:213], v126
ds_read_b64_tr_b16 v[214:215], v127
s_bitcmp1_b32 s51, 12
s_cbranch_scc0 L_rr_537
ds_read_b64_tr_b16 v[216:217], v128
ds_read_b64_tr_b16 v[218:219], v129
s_branch L_rr_537
L_m_538:
v_mfma_f32_16x16x32_bf16 v[4:7], v[232:235], v[244:247], v[4:7]
s_bitcmp1_b32 s51, 11
s_cbranch_scc0 L_mr_539
v_mfma_f32_16x16x32_bf16 v[4:7], v[236:239], v[244:247], v[4:7]
s_branch L_mr_539
L_r_540:
ds_read_b64_tr_b16 v[232:233], v136
ds_read_b64_tr_b16 v[234:235], v137
s_bitcmp1_b32 s51, 13
s_cbranch_scc0 L_rr_541
ds_read_b64_tr_b16 v[236:237], v138
ds_read_b64_tr_b16 v[238:239], v139
s_branch L_rr_541
L_m_542:
v_mfma_f32_16x16x32_bf16 v[4:7], v[212:215], v[248:251], v[4:7]
s_bitcmp1_b32 s51, 12
s_cbranch_scc0 L_mr_543
v_mfma_f32_16x16x32_bf16 v[4:7], v[216:219], v[248:251], v[4:7]
s_branch L_mr_543
L_r_544:
ds_read_b64_tr_b16 v[212:213], v146
ds_read_b64_tr_b16 v[214:215], v147
s_bitcmp1_b32 s51, 14
s_cbranch_scc0 L_rr_545
ds_read_b64_tr_b16 v[216:217], v148
ds_read_b64_tr_b16 v[218:219], v149
s_branch L_rr_545
L_m_546:
v_mfma_f32_16x16x32_bf16 v[4:7], v[232:235], v[252:255], v[4:7]
s_bitcmp1_b32 s51, 13
s_cbranch_scc0 L_mr_547
v_mfma_f32_16x16x32_bf16 v[4:7], v[236:239], v[252:255], v[4:7]
s_branch L_mr_547
L_r_548:
ds_read_b64_tr_b16 v[232:233], v156
ds_read_b64_tr_b16 v[234:235], v157
s_bitcmp1_b32 s51, 15
s_cbranch_scc0 L_rr_549
ds_read_b64_tr_b16 v[236:237], v158
ds_read_b64_tr_b16 v[238:239], v159
s_branch L_rr_549
L_m_550:
v_mfma_f32_16x16x32_bf16 v[8:11], v[212:215], v[240:243], v[8:11]
s_bitcmp1_b32 s51, 14
s_cbranch_scc0 L_mr_551
v_mfma_f32_16x16x32_bf16 v[8:11], v[216:219], v[240:243], v[8:11]
s_branch L_mr_551
L_a7_552:
s_nop 7
v_mul_f32 v4, v4, v30
v_mul_f32 v5, v5, v30
v_mul_f32 v6, v6, v30
v_mul_f32 v7, v7, v30
v_cvt_pk_bf16_f32 v24, v4, v5
v_cvt_pk_bf16_f32 v25, v6, v7
s_lshl_b32 s93, s44, 2
v_bfe_u32 v42, v1, 3, 2
v_add_u32 v42, s93, v42
v_lshlrev_b32 v47, 15, v42
v_mul_u32_u24 v49, 320, v42
v_and_b32 v42, 7, v1
v_lshl_add_u32 v47, v42, 4, v47
v_lshl_add_u32 v49, v42, 3, v49
v_add_u32 v49, 72048, v49
s_lshl_b32 s82, s2, 7
s_add_u32 s82, s82, 29360128
s_lshl_b32 s92, s48, 15
s_lshl_b32 s96, s49, 9
s_add_u32 s92, s92, s96
v_lshl_add_u32 v34, v96, 4, s92
v_mov_b32 v66, v23
v_mov_b32 v67, v23
s_lshl_b32 s96, s2, 8
s_lshr_b32 s97, s96, 2
s_add_u32 s97, s97, 65280
s_mov_b32 s92, 81920
v_mul_u32_u24 v41, 3277, v1
v_lshrrev_b32 v41, 16, v41
v_mul_u32_u24 v42, 20, v41
v_sub_u32 v42, v1, v42
v_add_u32 v41, s93, v41
v_mul_lo_u32 v41, v41, s92
v_mov_b32 v40, s97
v_mov_b32 v43, s96
v_cmp_gt_u32 vcc, 16, v42
s_nop 1
v_cndmask_b32 v50, v40, v43, vcc
s_mov_b64 s[80:81], vcc
v_lshl_add_u32 v50, v42, 4, v50
v_add_u32 v50, v50, v41
v_cmp_gt_u32 vcc, 12, v1
s_nop 1
v_cndmask_b32 v51, v40, v43, vcc
v_lshl_add_u32 v51, v1, 4, v51
s_add_u32 s93, s93, 3
s_mul_i32 s93, s93, 81920
s_add_u32 s93, s93, 64
v_add_u32 v51, s93, v51
s_branch L_a7r_553
L_r_554:
ds_read_b64_tr_b16 v[212:213], v166
ds_read_b64_tr_b16 v[214:215], v167
s_bitcmp1_b32 s51, 16
s_cbranch_scc0 L_rr_555
ds_read_b64_tr_b16 v[216:217], v168
ds_read_b64_tr_b16 v[218:219], v169
s_branch L_rr_555
L_m_556:
v_mfma_f32_16x16x32_bf16 v[8:11], v[232:235], v[244:247], v[8:11]
s_bitcmp1_b32 s51, 15
s_cbranch_scc0 L_mr_557
v_mfma_f32_16x16x32_bf16 v[8:11], v[236:239], v[244:247], v[8:11]
s_branch L_mr_557
L_r_558:
ds_read_b64_tr_b16 v[232:233], v176
ds_read_b64_tr_b16 v[234:235], v177
s_bitcmp1_b32 s51, 17
s_cbranch_scc0 L_rr_559
ds_read_b64_tr_b16 v[236:237], v178
ds_read_b64_tr_b16 v[238:239], v179
s_branch L_rr_559
L_m_560:
v_mfma_f32_16x16x32_bf16 v[8:11], v[212:215], v[248:251], v[8:11]
s_bitcmp1_b32 s51, 16
s_cbranch_scc0 L_mr_561
v_mfma_f32_16x16x32_bf16 v[8:11], v[216:219], v[248:251], v[8:11]
s_branch L_mr_561
L_r_562:
ds_read_b64_tr_b16 v[212:213], v186
ds_read_b64_tr_b16 v[214:215], v187
s_bitcmp1_b32 s51, 18
s_cbranch_scc0 L_rr_563
ds_read_b64_tr_b16 v[216:217], v188
ds_read_b64_tr_b16 v[218:219], v189
s_branch L_rr_563
L_m_564:
v_mfma_f32_16x16x32_bf16 v[8:11], v[232:235], v[252:255], v[8:11]
s_bitcmp1_b32 s51, 17
s_cbranch_scc0 L_mr_565
v_mfma_f32_16x16x32_bf16 v[8:11], v[236:239], v[252:255], v[8:11]
s_branch L_mr_565
L_pl_568:
buffer_load_dwordx2 v[94:95], v37, s[4:7], 0 offen sc1
s_add_u32 s57, s57, 1
s_cmp_gt_u32 s57, 4194304
s_cbranch_scc1 L_end
s_waitcnt vmcnt(0)
v_lshl_add_u64 v[40:41], v[94:95], 0, s[58:59]
v_cmp_le_u64 vcc, 64, v[40:41]
s_cbranch_vccnz L_pl_568
s_branch L_pd_569
L_xs_570:
s_nop 4
buffer_store_dwordx4 v[16:19], v33, s[4:7], s53 offen sc1
s_nop 1
s_branch L_xe_571
L_a7_566:
s_nop 7
v_mul_f32 v8, v8, v31
v_mul_f32 v9, v9, v31
v_mul_f32 v10, v10, v31
v_mul_f32 v11, v11, v31
v_cvt_pk_bf16_f32 v26, v8, v9
v_cvt_pk_bf16_f32 v27, v10, v11
s_cmp_lg_u32 s87, 0
s_cselect_b32 exec_lo, -1, 0
s_mov_b32 exec_hi, 0
buffer_load_dwordx2 v[92:93], v39, s[4:7], s40 offen sc1
s_mov_b64 exec, -1
buffer_store_dwordx4 v[24:27], v33, s[4:7], s54 offen sc1
s_branch L_a7r_567
L_r_572:
ds_read_b64_tr_b16 v[232:233], v196
ds_read_b64_tr_b16 v[234:235], v197
s_bitcmp1_b32 s51, 19
s_cbranch_scc0 L_rr_573
ds_read_b64_tr_b16 v[236:237], v198
ds_read_b64_tr_b16 v[238:239], v199
s_branch L_rr_573
L_m_574:
v_mfma_f32_16x16x32_bf16 v[12:15], v[212:215], v[240:243], v[12:15]
s_bitcmp1_b32 s51, 18
s_cbranch_scc0 L_mr_575
v_mfma_f32_16x16x32_bf16 v[12:15], v[216:219], v[240:243], v[12:15]
s_branch L_mr_575
L_xs_578:
s_nop 4
s_mov_b64 exec, 1
buffer_store_dwordx2 v[22:23], v38, s[4:7], 0 offen sc1
s_mov_b64 exec, -1
s_nop 1
s_branch L_xe_579
L_pl_582:
buffer_load_dwordx2 v[92:93], v39, s[4:7], s40 offen sc1
s_add_u32 s57, s57, 1
s_cmp_gt_u32 s57, 4194304
s_cbranch_scc1 L_end
s_waitcnt vmcnt(0)
v_lshl_add_u64 v[40:41], v[92:93], 0, s[58:59]
v_cmp_le_u64 vcc, 64, v[40:41]
s_cbranch_vccz L_pn_584
s_sleep 4
s_branch L_pl_582
L_pn_584:
s_branch L_pd_583
L_tc_580:
s_sub_u32 s58, 0, s87
s_mov_b32 exec_hi, 0
v_lshl_add_u64 v[40:41], v[92:93], 0, s[58:59]
v_cmp_le_u64 vcc, 64, v[40:41]
s_cbranch_vccnz L_pl_582
L_pd_583:
s_mov_b64 exec, -1
s_branch L_tcr_581
L_a7_576:
s_nop 7
s_branch L_a7r_577
L_m_585:
v_mfma_f32_16x16x32_bf16 v[12:15], v[232:235], v[244:247], v[12:15]
s_bitcmp1_b32 s51, 19
s_cbranch_scc0 L_mr_586
v_mfma_f32_16x16x32_bf16 v[12:15], v[236:239], v[244:247], v[12:15]
s_branch L_mr_586
L_xs_587:
s_nop 4
buffer_store_dwordx2 v[20:21], v34, s[4:7], s53 offen sc1
s_nop 1
s_branch L_xe_588
L_xs_589:
s_nop 4
s_mov_b64 exec, 1
buffer_store_dwordx2 v[22:23], v38, s[4:7], 0 offen sc1
s_mov_b64 exec, -1
s_nop 1
s_branch L_xe_590
L_pl_591:
buffer_load_dwordx2 v[94:95], v37, s[4:7], 0 offen sc1
s_add_u32 s57, s57, 1
s_cmp_gt_u32 s57, 4194304
s_cbranch_scc1 L_end
s_waitcnt vmcnt(0)
v_lshl_add_u64 v[40:41], v[94:95], 0, s[58:59]
v_cmp_le_u64 vcc, 64, v[40:41]
s_cbranch_vccnz L_pl_591
s_branch L_pd_592
L_pl_593:
buffer_load_dwordx2 v[94:95], v39, s[4:7], 0 offen sc1
s_add_u32 s57, s57, 1
s_cmp_gt_u32 s57, 4194304
s_cbranch_scc1 L_end
s_waitcnt vmcnt(0)
v_lshl_add_u64 v[40:41], v[94:95], 0, s[58:59]
v_cmp_le_u64 vcc, 64, v[40:41]
s_cbranch_vccnz L_pl_593
s_branch L_pd_594
L_bxw:
ds_write_b64 v54, v[46:47]
ds_write_b64 v54, v[48:49] offset:320
ds_write_b64 v55, v[50:51] offset:256
ds_write_b64 v55, v[52:53] offset:576
s_mov_b32 s41, 99
s_branch L_prepB_back
L_prepW:
s_cmp_eq_u32 s52, 1
s_cbranch_scc1 L_prepB_back
s_cmp_eq_u32 s41, 17
s_cbranch_scc1 L_bxw
s_cmp_eq_u32 s52, 2
s_cbranch_scc1 L_prepB
s_cmp_eq_u32 s41, 16
s_cbranch_scc1 L_prepB_back
s_cmp_eq_u32 s52, 3
s_cbranch_scc1 L_prepB2
s_cmp_eq_u32 s52, 4
s_cbranch_scc1 L_prepC
s_branch L_prepB_back
L_xs_597:
s_nop 4
buffer_store_dwordx4 v[16:19], v33, s[4:7], s53 offen sc1
s_nop 1
s_branch L_xe_598
L_xs_599:
s_nop 4
s_mov_b64 exec, 1
buffer_store_dwordx2 v[22:23], v38, s[4:7], 0 offen sc1
s_mov_b64 exec, -1
s_nop 1
s_branch L_xe_600
L_pl_603:
buffer_load_dwordx2 v[92:93], v39, s[4:7], s40 offen sc1
s_add_u32 s57, s57, 1
s_cmp_gt_u32 s57, 4194304
s_cbranch_scc1 L_end
s_waitcnt vmcnt(0)
v_lshl_add_u64 v[40:41], v[92:93], 0, s[58:59]
v_cmp_le_u64 vcc, 64, v[40:41]
s_cbranch_vccz L_pn_605
s_sleep 4
s_branch L_pl_603
L_pn_605:
s_branch L_pd_604
L_tc_601:
s_sub_u32 s58, 0, s87
s_mov_b32 exec_hi, 0
v_lshl_add_u64 v[40:41], v[92:93], 0, s[58:59]
v_cmp_le_u64 vcc, 64, v[40:41]
s_cbranch_vccnz L_pl_603
L_pd_604:
s_mov_b64 exec, -1
s_branch L_tcr_602
    s_nop 0
L_gath7_done:
    s_mov_b32 s94, 29360128
    s_nop 4
    v_mul_f32 v12, v12, v32
    v_mul_f32 v13, v13, v32
    v_mul_f32 v14, v14, v32
    v_mul_f32 v15, v15, v32
    v_cvt_pk_bf16_f32 v64, v12, v13
    v_cvt_pk_bf16_f32 v65, v14, v15
    s_waitcnt vmcnt(0)
    buffer_store_dwordx4 v[64:67], v34, s[4:7], s94 offen sc1
    s_cmp_lg_u32 s87, 0
    s_cbranch_scc1 L_tc_606
L_tcr_607:
    s_barrier
    s_mov_b32 s95, 4
    s_mul_i32 s92, s95, 2621440
    s_add_u32 s92, s92, 8388608
    s_mul_i32 s93, s95, 10256
    s_lshl_b32 s94, s44, 10
    s_add_u32 s93, s93, s94
    s_mov_b32 m0, s93
    s_cmp_ge_u32 s44, 2
    buffer_load_dwordx4 v97, s[4:7], s92 offen sc1 lds
    s_cbranch_scc1 L_sp_611
    s_add_u32 m0, s93, 8192
    s_cmp_lg_u32 0, 0
    buffer_load_dwordx4 v98, s[4:7], s92 offen sc1 lds
L_sp_611:
    s_mov_b32 s95, 5
    s_mul_i32 s92, s95, 2621440
    s_add_u32 s92, s92, 8388608
    s_mul_i32 s93, s95, 10256
    s_lshl_b32 s94, s44, 10
    s_add_u32 s93, s93, s94
    s_mov_b32 m0, s93
    s_cmp_ge_u32 s44, 2
    buffer_load_dwordx4 v97, s[4:7], s92 offen sc1 lds
    s_cbranch_scc1 L_sp_612
    s_add_u32 m0, s93, 8192
    s_cmp_lg_u32 0, 0
    buffer_load_dwordx4 v98, s[4:7], s92 offen sc1 lds
L_sp_612:
    v_lshlrev_b32 v42, 4, v1
    s_lshl_b32 s92, s44, 13
    s_add_u32 s93, s92, 262144
    s_add_u32 s92, s92, 82176
    s_mov_b32 m0, s92
    s_add_u32 s94, s93, 4096
    buffer_load_dwordx4 v42, s[4:7], s93 offen offset:0 sc1 lds
    buffer_load_dwordx4 v42, s[4:7], s93 offen offset:1024 sc1 lds
    buffer_load_dwordx4 v42, s[4:7], s93 offen offset:2048 sc1 lds
    buffer_load_dwordx4 v42, s[4:7], s93 offen offset:3072 sc1 lds
    s_add_u32 m0, s92, 4096
    s_nop 0
    buffer_load_dwordx4 v42, s[4:7], s94 offen offset:0 sc1 lds
    buffer_load_dwordx4 v42, s[4:7], s94 offen offset:1024 sc1 lds
    buffer_load_dwordx4 v42, s[4:7], s94 offen offset:2048 sc1 lds
    buffer_load_dwordx4 v42, s[4:7], s94 offen offset:3072 sc1 lds
    s_and_b32 s92, s44, 3
    s_lshl_b32 s92, s92, 10
    s_add_u32 s93, s92, 327680
    s_add_u32 m0, s92, 147712
    v_mov_b32 v43, 331776
    buffer_load_dwordx4 v42, s[4:7], s93 offen sc1 lds
    buffer_load_dword v10, v43, s[4:7], 0 offen sc1
    s_lshr_b32 s78, s2, 2
    s_and_b32 s79, s2, 3
    v_and_b32 v11, 15, v1
    v_lshrrev_b32 v12, 4, v1
    v_and_b32 v13, 7, v11
    v_mul_u32_u24 v13, 10256, v13
    v_mul_u32_u24 v14, 640, v12
    v_add_u32 v2, v13, v14
    v_lshrrev_b32 v13, 3, v11
    v_lshl_add_u32 v2, v13, 3, v2
    s_lshl_b32 s92, s44, 4
    s_add_u32 s92, s92, 0
    v_add_u32 v2, s92, v2
    v_bfe_u32 v13, v1, 2, 3
    v_mul_u32_u24 v13, 10256, v13
    v_and_b32 v14, 3, v1
    v_mul_u32_u24 v14, 640, v14
    v_add_u32 v3, v13, v14
    v_lshrrev_b32 v13, 5, v1
    v_lshl_add_u32 v3, v13, 3, v3
    v_add_u32 v3, s92, v3
    v_lshlrev_b32 v4, 4, v1
    v_add_u32 v4, 82176, v4
    s_mul_i32 s92, s44, 768
    s_add_u32 s92, s92, 151808
    v_lshl_add_u32 v6, v11, 2, s92
    v_lshl_add_u32 v7, v12, 4, s92
    v_xor_b32 v13, 1, v12
    v_lshl_add_u32 v8, v13, 4, s92
    v_lshrrev_b32 v13, 2, v11
    v_cmp_eq_u32 vcc, v13, v12
    v_add_u32 v14, 128, v6
    s_nop 0
    v_cndmask_b32 v5, v14, v6, vcc
    v_and_b32 v13, 3, v11
    v_cmp_eq_u32 s[60:61], 1, v13
    v_cmp_eq_u32 s[62:63], 2, v13
    v_cmp_eq_u32 s[64:65], 3, v13
    v_lshrrev_b32 v13, 3, v11
    v_lshrrev_b32 v14, 1, v12
    v_cmp_eq_u32 s[66:67], v13, v14
    v_sub_u32 v13, v11, v14
    v_cmp_eq_u32 s[68:69], 0, v13
    v_cmp_eq_u32 s[70:71], 2, v13
    v_cmp_eq_u32 s[72:73], 4, v13
    v_lshrrev_b32 v13, 1, v11
    v_lshlrev_b32 v13, 4, v13
    v_and_b32 v14, 1, v11
    v_add_u32 v13, v13, v14
    s_lshl_b32 s92, s44, 1
    v_add_u32 v13, s92, v13
    s_lshl_b32 s92, s78, 7
    s_lshl_b32 s93, s79, 5
    s_add_u32 s92, s92, s93
    s_lshr_b32 s93, s92, 2
    s_add_u32 s93, s93, 8160
    v_mov_b32 v14, s93
    v_mov_b32 v9, s92
    v_cmp_gt_u32 vcc, 32, v13
    s_nop 1
    v_cndmask_b32 v14, v14, v9, vcc
    v_add_u32 v14, v14, v13
    v_lshlrev_b32 v14, 8, v14
    v_lshl_add_u32 v14, v12, 4, v14
    v_mov_b32 v9, 0x40000000
    v_cmp_gt_u32 vcc, 40, v13
    s_nop 1
    v_cndmask_b32 v9, v9, v14, vcc
    s_mov_b32 s74, 0x3c000000
    s_mov_b32 s75, 0x3727c5ac
    s_mov_b32 s76, 0x3e0293ee
    s_mov_b32 s77, 0x3fb8aa3b
    v_mov_b32 v16, 0x3f803f80
    v_mov_b32 v17, 0x3f803f80
    v_mov_b32 v18, 0x3f803f80
    v_mov_b32 v19, 0x3f803f80
    v_and_b32 v13, 15, v1
    v_lshrrev_b32 v14, 4, v1
    v_lshlrev_b32 v14, 2, v14
    v_sub_u32 v13, v13, v14
    v_mov_b32 v14, 0x3f80
    v_cmp_eq_u32 vcc, 0, v13
    s_nop 1
    v_cndmask_b32 v176, 0, v14, vcc
    v_cmp_eq_u32 vcc, 2, v13
    s_nop 1
    v_cndmask_b32 v177, 0, v14, vcc
    v_mov_b32 v14, 0x3f800000
    v_cmp_eq_u32 vcc, 1, v13
    s_nop 1
    v_cndmask_b32 v176, v176, v14, vcc
    v_cmp_eq_u32 vcc, 3, v13
    s_nop 1
    v_cndmask_b32 v177, v177, v14, vcc
    v_mov_b32 v192, v176
    v_mov_b32 v193, v177
    v_mov_b32 v208, v176
    v_mov_b32 v209, v177
    s_mov_b32 exec_hi, 0
    buffer_load_dwordx4 v[76:79], v47, s[4:7], s82 offen sc1
    s_waitcnt vmcnt(0)
    v_xor_b32 v40, v78, v23
    v_xor_b32 v41, v79, v23
    v_or_b32 v40, v40, v41
    v_cmp_ne_u32 vcc, 0, v40
    s_cbranch_vccnz L_x7again
    s_nop 3
L_x7ok:
    ds_write_b64 v49, v[76:77]
    s_mov_b64 exec, -1
    s_mul_i32 s93, s44, 1280
    s_mov_b32 s92, 24117248
    s_mov_b32 s94, 26738688
    s_add_u32 m0, s93, 61536
    s_nop 0
    buffer_load_dwordx4 v50, s[4:7], s92 offen sc1 lds
    s_add_u32 m0, s93, 71792
    s_mov_b64 exec, s[80:81]
    buffer_load_dwordx4 v50, s[4:7], s94 offen sc1 lds
    s_add_u32 m0, s93, 62560
    s_mov_b64 exec, 0xffff
    buffer_load_dwordx4 v51, s[4:7], s92 offen sc1 lds
    s_add_u32 m0, s93, 72816
    s_mov_b64 exec, 0xfff
    buffer_load_dwordx4 v51, s[4:7], s94 offen sc1 lds
    s_mov_b64 exec, -1
    s_waitcnt vmcnt(0) lgkmcnt(0)
    s_barrier
    s_cmp_ge_u32 s44, 4
    s_cbranch_scc1 L_tf_two
    ds_read_b64 v[20:21], v2 offset:0
    ds_read_b64 v[22:23], v2 offset:320
    ds_read_b64 v[24:25], v2 offset:2560
    ds_read_b64 v[26:27], v2 offset:2880
    ds_read_b64 v[28:29], v2 offset:5120
    ds_read_b64 v[30:31], v2 offset:5440
    ds_read_b64 v[32:33], v2 offset:7680
    ds_read_b64 v[34:35], v2 offset:8000
    ds_read_b64 v[36:37], v2 offset:128
    ds_read_b64 v[38:39], v2 offset:448
    ds_read_b64 v[40:41], v2 offset:2688
    ds_read_b64 v[42:43], v2 offset:3008
    ds_read_b64 v[44:45], v2 offset:5248
    ds_read_b64 v[46:47], v2 offset:5568
    ds_read_b64 v[48:49], v2 offset:7808
    ds_read_b64 v[50:51], v2 offset:8128
    ds_read_b64 v[52:53], v2 offset:256
    ds_read_b64 v[54:55], v2 offset:576
    ds_read_b64 v[56:57], v2 offset:2816
    ds_read_b64 v[58:59], v2 offset:3136
    ds_read_b64 v[60:61], v2 offset:5376
    ds_read_b64 v[62:63], v2 offset:5696
    ds_read_b64 v[64:65], v2 offset:7936
    ds_read_b64 v[66:67], v2 offset:8256
    ds_read_b128 v[212:215], v4 offset:0
    ds_read_b128 v[216:219], v4 offset:1024
    ds_read_b128 v[220:223], v4 offset:2048
    ds_read_b128 v[224:227], v4 offset:3072
    s_waitcnt lgkmcnt(15)
    v_mfma_f32_16x16x32_bf16 v[76:79], v[20:23], v[20:23], 0
    v_mfma_f32_16x16x32_bf16 v[76:79], v[24:27], v[24:27], v[76:79]
    v_mfma_f32_16x16x32_bf16 v[76:79], v[28:31], v[28:31], v[76:79]
    v_mfma_f32_16x16x32_bf16 v[76:79], v[32:35], v[32:35], v[76:79]
    v_mfma_f32_16x16x32_bf16 v[80:83], v[16:19], v[20:23], 0
    v_mfma_f32_16x16x32_bf16 v[80:83], v[16:19], v[24:27], v[80:83]
    v_mfma_f32_16x16x32_bf16 v[80:83], v[16:19], v[28:31], v[80:83]
    v_mfma_f32_16x16x32_bf16 v[80:83], v[16:19], v[32:35], v[80:83]
    v_mfma_f32_16x16x32_bf16 v[108:111], v[36:39], v[36:39], 0
    v_mfma_f32_16x16x32_bf16 v[108:111], v[40:43], v[40:43], v[108:111]
    s_waitcnt lgkmcnt(14)
    v_mfma_f32_16x16x32_bf16 v[108:111], v[44:47], v[44:47], v[108:111]
    s_waitcnt lgkmcnt(12)
    v_mfma_f32_16x16x32_bf16 v[108:111], v[48:51], v[48:51], v[108:111]
    v_mfma_f32_16x16x32_bf16 v[112:115], v[16:19], v[36:39], 0
    v_mfma_f32_16x16x32_bf16 v[112:115], v[16:19], v[40:43], v[112:115]
    v_mfma_f32_16x16x32_bf16 v[112:115], v[16:19], v[44:47], v[112:115]
    v_mfma_f32_16x16x32_bf16 v[112:115], v[16:19], v[48:51], v[112:115]
    s_waitcnt lgkmcnt(10)
    v_mfma_f32_16x16x32_bf16 v[140:143], v[52:55], v[52:55], 0
    s_waitcnt lgkmcnt(8)
    v_mfma_f32_16x16x32_bf16 v[140:143], v[56:59], v[56:59], v[140:143]
    s_waitcnt lgkmcnt(6)
    v_mfma_f32_16x16x32_bf16 v[140:143], v[60:63], v[60:63], v[140:143]
    s_waitcnt lgkmcnt(4)
    v_mfma_f32_16x16x32_bf16 v[140:143], v[64:67], v[64:67], v[140:143]
    v_mfma_f32_16x16x32_bf16 v[144:147], v[16:19], v[52:55], 0
    v_mfma_f32_16x16x32_bf16 v[144:147], v[16:19], v[56:59], v[144:147]
    v_mfma_f32_16x16x32_bf16 v[144:147], v[16:19], v[60:63], v[144:147]
    v_mfma_f32_16x16x32_bf16 v[144:147], v[16:19], v[64:67], v[144:147]
    s_waitcnt lgkmcnt(0)
    v_cndmask_b32 v76, v76, v77, s[60:61]
    v_mfma_f32_16x16x32_bf16 v[68:71], v[212:215], v[20:23], 0
    v_mul_f32 v80, s74, v80
    ds_read_b128 v[228:231], v4 offset:4096
    v_cndmask_b32 v76, v76, v78, s[62:63]
    v_mfma_f32_16x16x32_bf16 v[68:71], v[216:219], v[24:27], v[68:71]
    v_mul_f32 v81, v80, v80
    ds_read_b128 v[232:235], v4 offset:5120
    v_cndmask_b32 v76, v76, v79, s[64:65]
    v_fma_f32 v76, v76, s74, -v81
    v_mfma_f32_16x16x32_bf16 v[68:71], v[220:223], v[28:31], v[68:71]
    v_max_f32 v76, 0, v76
    ds_read_b128 v[236:239], v4 offset:6144
    v_add_f32 v76, s75, v76
    v_mfma_f32_16x16x32_bf16 v[68:71], v[224:227], v[32:35], v[68:71]
    v_rsq_f32 v76, v76
    ds_read_b128 v[240:243], v4 offset:7168
    v_mul_f32 v80, v80, v76
    ds_write2_b32 v5, v76, v80 offset0:0 offset1:16
    v_mfma_f32_16x16x32_bf16 v[100:103], v[212:215], v[36:39], 0
    ds_read_b32 v92, v6 offset:0
    v_mfma_f32_16x16x32_bf16 v[100:103], v[216:219], v[40:43], v[100:103]
    ds_read_b128 v[168:171], v7 offset:0
    v_mfma_f32_16x16x32_bf16 v[100:103], v[220:223], v[44:47], v[100:103]
    ds_read_b128 v[172:175], v7 offset:64
    v_mfma_f32_16x16x32_bf16 v[100:103], v[224:227], v[48:51], v[100:103]
    v_cndmask_b32 v108, v108, v109, s[60:61]
    v_mul_f32 v112, s74, v112
    v_mfma_f32_16x16x32_bf16 v[132:135], v[212:215], v[52:55], 0
    v_cndmask_b32 v108, v108, v110, s[62:63]
    v_mfma_f32_16x16x32_bf16 v[132:135], v[216:219], v[56:59], v[132:135]
    v_mul_f32 v113, v112, v112
    v_mfma_f32_16x16x32_bf16 v[132:135], v[220:223], v[60:63], v[132:135]
    v_cndmask_b32 v108, v108, v111, s[64:65]
    v_mfma_f32_16x16x32_bf16 v[132:135], v[224:227], v[64:67], v[132:135]
    v_fma_f32 v108, v108, s74, -v113
    v_max_f32 v108, 0, v108
    s_waitcnt lgkmcnt(4)
    v_add_f32 v108, s75, v108
    v_mfma_f32_16x16x32_bf16 v[72:75], v[228:231], v[20:23], 0
    v_rsq_f32 v108, v108
    ds_read_b128 v[212:215], v4 offset:8192
    v_mul_f32 v112, v112, v108
    v_mfma_f32_16x16x32_bf16 v[72:75], v[232:235], v[24:27], v[72:75]
    ds_write2_b32 v5, v108, v112 offset0:64 offset1:80
    ds_read_b128 v[216:219], v4 offset:9216
    ds_read_b32 v124, v6 offset:256
    ds_read_b128 v[184:187], v7 offset:256
    v_mfma_f32_16x16x32_bf16 v[72:75], v[236:239], v[28:31], v[72:75]
    ds_read_b128 v[188:191], v7 offset:320
    ds_read_b128 v[220:223], v4 offset:10240
    v_cndmask_b32 v140, v140, v141, s[60:61]
    v_mfma_f32_16x16x32_bf16 v[72:75], v[240:243], v[32:35], v[72:75]
    v_mul_f32 v144, s74, v144
    ds_read_b128 v[224:227], v4 offset:11264
    v_cndmask_b32 v140, v140, v142, s[62:63]
    v_mul_f32 v145, v144, v144
    v_mfma_f32_16x16x32_bf16 v[104:107], v[228:231], v[36:39], 0
    v_cndmask_b32 v140, v140, v143, s[64:65]
    v_mfma_f32_16x16x32_bf16 v[104:107], v[232:235], v[40:43], v[104:107]
    v_fma_f32 v140, v140, s74, -v145
    v_mfma_f32_16x16x32_bf16 v[104:107], v[236:239], v[44:47], v[104:107]
    v_max_f32 v140, 0, v140
    v_mfma_f32_16x16x32_bf16 v[104:107], v[240:243], v[48:51], v[104:107]
    v_add_f32 v140, s75, v140
    v_rsq_f32 v140, v140
    v_mfma_f32_16x16x32_bf16 v[136:139], v[228:231], v[52:55], 0
    v_mul_f32 v144, v144, v140
    v_mfma_f32_16x16x32_bf16 v[136:139], v[232:235], v[56:59], v[136:139]
    ds_write2_b32 v5, v140, v144 offset0:128 offset1:144
    v_mfma_f32_16x16x32_bf16 v[136:139], v[236:239], v[60:63], v[136:139]
    ds_read_b32 v156, v6 offset:512
    v_mfma_f32_16x16x32_bf16 v[136:139], v[240:243], v[64:67], v[136:139]
    ds_read_b128 v[200:203], v7 offset:512
    ds_read_b128 v[204:207], v7 offset:576
    s_waitcnt lgkmcnt(4)
    v_mfma_f32_16x16x32_bf16 v[76:79], v[212:215], v[20:23], 0
    ds_read_b128 v[228:231], v4 offset:12288
    v_mfma_f32_16x16x32_bf16 v[76:79], v[216:219], v[24:27], v[76:79]
    v_cvt_pk_bf16_f32 v84, v68, v69
    ds_read_b128 v[232:235], v4 offset:13312
    v_cvt_pk_bf16_f32 v85, v70, v71
    v_mfma_f32_16x16x32_bf16 v[76:79], v[220:223], v[28:31], v[76:79]
    ds_read_b128 v[236:239], v4 offset:14336
    v_cvt_pk_bf16_f32 v86, v72, v73
    v_mfma_f32_16x16x32_bf16 v[76:79], v[224:227], v[32:35], v[76:79]
    v_cvt_pk_bf16_f32 v87, v74, v75
    ds_read_b128 v[240:243], v4 offset:15360
    v_cvt_pk_bf16_f32 v116, v100, v101
    v_mfma_f32_16x16x32_bf16 v[108:111], v[212:215], v[36:39], 0
    v_cvt_pk_bf16_f32 v117, v102, v103
    v_mfma_f32_16x16x32_bf16 v[108:111], v[216:219], v[40:43], v[108:111]
    v_cvt_pk_bf16_f32 v118, v104, v105
    v_mfma_f32_16x16x32_bf16 v[108:111], v[220:223], v[44:47], v[108:111]
    v_mfma_f32_16x16x32_bf16 v[108:111], v[224:227], v[48:51], v[108:111]
    v_cvt_pk_bf16_f32 v119, v106, v107
    v_mfma_f32_16x16x32_bf16 v[140:143], v[212:215], v[52:55], 0
    v_cvt_pk_bf16_f32 v148, v132, v133
    v_mfma_f32_16x16x32_bf16 v[140:143], v[216:219], v[56:59], v[140:143]
    v_cvt_pk_bf16_f32 v149, v134, v135
    v_mfma_f32_16x16x32_bf16 v[140:143], v[220:223], v[60:63], v[140:143]
    v_cvt_pk_bf16_f32 v150, v136, v137
    v_mfma_f32_16x16x32_bf16 v[140:143], v[224:227], v[64:67], v[140:143]
    v_cvt_pk_bf16_f32 v151, v138, v139
    v_mfma_f32_16x16x32_bf16 v[164:167], v[20:23], v[84:87], 0
    v_mfma_f32_16x16x32_bf16 v[96:99], v[16:19], v[84:87], 0
    v_mfma_f32_16x16x32_bf16 v[180:183], v[36:39], v[116:119], 0
    v_mfma_f32_16x16x32_bf16 v[128:131], v[16:19], v[116:119], 0
    v_mfma_f32_16x16x32_bf16 v[196:199], v[52:55], v[148:151], 0
    v_mfma_f32_16x16x32_bf16 v[160:163], v[16:19], v[148:151], 0
    s_waitcnt lgkmcnt(0)
    v_mfma_f32_16x16x32_bf16 v[80:83], v[228:231], v[20:23], 0
    ds_read_b128 v[212:215], v4 offset:16384
    v_mfma_f32_16x16x32_bf16 v[80:83], v[232:235], v[24:27], v[80:83]
    ds_read_b128 v[216:219], v4 offset:17408
    v_mfma_f32_16x16x32_bf16 v[80:83], v[236:239], v[28:31], v[80:83]
    ds_read_b128 v[220:223], v4 offset:18432
    v_mfma_f32_16x16x32_bf16 v[80:83], v[240:243], v[32:35], v[80:83]
    ds_read_b128 v[224:227], v4 offset:19456
    v_mfma_f32_16x16x32_bf16 v[112:115], v[228:231], v[36:39], 0
    v_mfma_f32_16x16x32_bf16 v[112:115], v[232:235], v[40:43], v[112:115]
    v_mfma_f32_16x16x32_bf16 v[112:115], v[236:239], v[44:47], v[112:115]
    v_mfma_f32_16x16x32_bf16 v[112:115], v[240:243], v[48:51], v[112:115]
    v_mfma_f32_16x16x32_bf16 v[144:147], v[228:231], v[52:55], 0
    v_mfma_f32_16x16x32_bf16 v[144:147], v[232:235], v[56:59], v[144:147]
    v_mfma_f32_16x16x32_bf16 v[144:147], v[236:239], v[60:63], v[144:147]
    v_mfma_f32_16x16x32_bf16 v[144:147], v[240:243], v[64:67], v[144:147]
    s_waitcnt lgkmcnt(0)
    v_mfma_f32_16x16x32_bf16 v[68:71], v[212:215], v[20:23], 0
    ds_read_b128 v[228:231], v4 offset:20480
    v_mfma_f32_16x16x32_bf16 v[68:71], v[216:219], v[24:27], v[68:71]
    v_cvt_pk_bf16_f32 v88, v76, v77
    ds_read_b128 v[232:235], v4 offset:21504
    v_cvt_pk_bf16_f32 v89, v78, v79
    v_mfma_f32_16x16x32_bf16 v[68:71], v[220:223], v[28:31], v[68:71]
    ds_read_b128 v[236:239], v4 offset:22528
    v_cvt_pk_bf16_f32 v90, v80, v81
    v_mfma_f32_16x16x32_bf16 v[68:71], v[224:227], v[32:35], v[68:71]
    v_cvt_pk_bf16_f32 v91, v82, v83
    ds_read_b128 v[240:243], v4 offset:23552
    v_cvt_pk_bf16_f32 v120, v108, v109
    v_mfma_f32_16x16x32_bf16 v[100:103], v[212:215], v[36:39], 0
    v_cvt_pk_bf16_f32 v121, v110, v111
    v_mfma_f32_16x16x32_bf16 v[100:103], v[216:219], v[40:43], v[100:103]
    v_cvt_pk_bf16_f32 v122, v112, v113
    v_mfma_f32_16x16x32_bf16 v[100:103], v[220:223], v[44:47], v[100:103]
    v_mfma_f32_16x16x32_bf16 v[100:103], v[224:227], v[48:51], v[100:103]
    v_cvt_pk_bf16_f32 v123, v114, v115
    v_mfma_f32_16x16x32_bf16 v[132:135], v[212:215], v[52:55], 0
    v_cvt_pk_bf16_f32 v152, v140, v141
    v_mfma_f32_16x16x32_bf16 v[132:135], v[216:219], v[56:59], v[132:135]
    v_cvt_pk_bf16_f32 v153, v142, v143
    v_mfma_f32_16x16x32_bf16 v[132:135], v[220:223], v[60:63], v[132:135]
    v_cvt_pk_bf16_f32 v154, v144, v145
    v_mfma_f32_16x16x32_bf16 v[132:135], v[224:227], v[64:67], v[132:135]
    v_cvt_pk_bf16_f32 v155, v146, v147
    v_mfma_f32_16x16x32_bf16 v[164:167], v[24:27], v[88:91], v[164:167]
    v_mfma_f32_16x16x32_bf16 v[96:99], v[16:19], v[88:91], v[96:99]
    v_mfma_f32_16x16x32_bf16 v[180:183], v[40:43], v[120:123], v[180:183]
    v_mfma_f32_16x16x32_bf16 v[128:131], v[16:19], v[120:123], v[128:131]
    v_mfma_f32_16x16x32_bf16 v[196:199], v[56:59], v[152:155], v[196:199]
    v_mfma_f32_16x16x32_bf16 v[160:163], v[16:19], v[152:155], v[160:163]
    s_waitcnt lgkmcnt(0)
    v_mfma_f32_16x16x32_bf16 v[72:75], v[228:231], v[20:23], 0
    ds_read_b128 v[212:215], v4 offset:24576
    v_mfma_f32_16x16x32_bf16 v[72:75], v[232:235], v[24:27], v[72:75]
    ds_read_b128 v[216:219], v4 offset:25600
    v_mfma_f32_16x16x32_bf16 v[72:75], v[236:239], v[28:31], v[72:75]
    ds_read_b128 v[220:223], v4 offset:26624
    v_mfma_f32_16x16x32_bf16 v[72:75], v[240:243], v[32:35], v[72:75]
    ds_read_b128 v[224:227], v4 offset:27648
    v_mfma_f32_16x16x32_bf16 v[104:107], v[228:231], v[36:39], 0
    v_mfma_f32_16x16x32_bf16 v[104:107], v[232:235], v[40:43], v[104:107]
    v_mfma_f32_16x16x32_bf16 v[104:107], v[236:239], v[44:47], v[104:107]
    v_mfma_f32_16x16x32_bf16 v[104:107], v[240:243], v[48:51], v[104:107]
    v_mfma_f32_16x16x32_bf16 v[136:139], v[228:231], v[52:55], 0
    v_mfma_f32_16x16x32_bf16 v[136:139], v[232:235], v[56:59], v[136:139]
    v_mfma_f32_16x16x32_bf16 v[136:139], v[236:239], v[60:63], v[136:139]
    v_mfma_f32_16x16x32_bf16 v[136:139], v[240:243], v[64:67], v[136:139]
    s_waitcnt lgkmcnt(0)
    v_mfma_f32_16x16x32_bf16 v[76:79], v[212:215], v[20:23], 0
    ds_read_b128 v[228:231], v4 offset:28672
    v_mfma_f32_16x16x32_bf16 v[76:79], v[216:219], v[24:27], v[76:79]
    v_cvt_pk_bf16_f32 v84, v68, v69
    ds_read_b128 v[232:235], v4 offset:29696
    v_cvt_pk_bf16_f32 v85, v70, v71
    v_mfma_f32_16x16x32_bf16 v[76:79], v[220:223], v[28:31], v[76:79]
    ds_read_b128 v[236:239], v4 offset:30720
    v_cvt_pk_bf16_f32 v86, v72, v73
    v_mfma_f32_16x16x32_bf16 v[76:79], v[224:227], v[32:35], v[76:79]
    v_cvt_pk_bf16_f32 v87, v74, v75
    ds_read_b128 v[240:243], v4 offset:31744
    v_cvt_pk_bf16_f32 v116, v100, v101
    v_mfma_f32_16x16x32_bf16 v[108:111], v[212:215], v[36:39], 0
    v_cvt_pk_bf16_f32 v117, v102, v103
    v_mfma_f32_16x16x32_bf16 v[108:111], v[216:219], v[40:43], v[108:111]
    v_cvt_pk_bf16_f32 v118, v104, v105
    v_mfma_f32_16x16x32_bf16 v[108:111], v[220:223], v[44:47], v[108:111]
    v_mfma_f32_16x16x32_bf16 v[108:111], v[224:227], v[48:51], v[108:111]
    v_cvt_pk_bf16_f32 v119, v106, v107
    v_mfma_f32_16x16x32_bf16 v[140:143], v[212:215], v[52:55], 0
    v_cvt_pk_bf16_f32 v148, v132, v133
    v_mfma_f32_16x16x32_bf16 v[140:143], v[216:219], v[56:59], v[140:143]
    v_cvt_pk_bf16_f32 v149, v134, v135
    v_mfma_f32_16x16x32_bf16 v[140:143], v[220:223], v[60:63], v[140:143]
    v_cvt_pk_bf16_f32 v150, v136, v137
    v_mfma_f32_16x16x32_bf16 v[140:143], v[224:227], v[64:67], v[140:143]
    v_cvt_pk_bf16_f32 v151, v138, v139
    v_mfma_f32_16x16x32_bf16 v[164:167], v[28:31], v[84:87], v[164:167]
    v_mfma_f32_16x16x32_bf16 v[96:99], v[16:19], v[84:87], v[96:99]
    v_mfma_f32_16x16x32_bf16 v[180:183], v[44:47], v[116:119], v[180:183]
    v_mfma_f32_16x16x32_bf16 v[128:131], v[16:19], v[116:119], v[128:131]
    v_mfma_f32_16x16x32_bf16 v[196:199], v[60:63], v[148:151], v[196:199]
    v_mfma_f32_16x16x32_bf16 v[160:163], v[16:19], v[148:151], v[160:163]
    s_waitcnt lgkmcnt(0)
    v_mfma_f32_16x16x32_bf16 v[80:83], v[228:231], v[20:23], 0
    ds_read_b128 v[212:215], v4 offset:32768
    v_mfma_f32_16x16x32_bf16 v[80:83], v[232:235], v[24:27], v[80:83]
    ds_read_b128 v[216:219], v4 offset:33792
    v_mfma_f32_16x16x32_bf16 v[80:83], v[236:239], v[28:31], v[80:83]
    ds_read_b128 v[220:223], v4 offset:34816
    v_mfma_f32_16x16x32_bf16 v[80:83], v[240:243], v[32:35], v[80:83]
    ds_read_b128 v[224:227], v4 offset:35840
    v_mfma_f32_16x16x32_bf16 v[112:115], v[228:231], v[36:39], 0
    v_mfma_f32_16x16x32_bf16 v[112:115], v[232:235], v[40:43], v[112:115]
    v_mfma_f32_16x16x32_bf16 v[112:115], v[236:239], v[44:47], v[112:115]
    v_mfma_f32_16x16x32_bf16 v[112:115], v[240:243], v[48:51], v[112:115]
    v_mfma_f32_16x16x32_bf16 v[144:147], v[228:231], v[52:55], 0
    v_mfma_f32_16x16x32_bf16 v[144:147], v[232:235], v[56:59], v[144:147]
    v_mfma_f32_16x16x32_bf16 v[144:147], v[236:239], v[60:63], v[144:147]
    v_mfma_f32_16x16x32_bf16 v[144:147], v[240:243], v[64:67], v[144:147]
    s_waitcnt lgkmcnt(0)
    v_mfma_f32_16x16x32_bf16 v[244:247], v[20:23], v[212:215], 0
    ds_read_b128 v[228:231], v4 offset:36864
    v_mfma_f32_16x16x32_bf16 v[244:247], v[24:27], v[216:219], v[244:247]
    ds_read_b128 v[232:235], v4 offset:37888
    v_cvt_pk_bf16_f32 v88, v76, v77
    v_mfma_f32_16x16x32_bf16 v[244:247], v[28:31], v[220:223], v[244:247]
    v_cvt_pk_bf16_f32 v89, v78, v79
    ds_read_b128 v[236:239], v4 offset:38912
    v_cvt_pk_bf16_f32 v90, v80, v81
    v_mfma_f32_16x16x32_bf16 v[244:247], v[32:35], v[224:227], v[244:247]
    ds_read_b128 v[240:243], v4 offset:39936
    v_cvt_pk_bf16_f32 v91, v82, v83
    v_mfma_f32_16x16x32_bf16 v[248:251], v[36:39], v[212:215], 0
    v_cvt_pk_bf16_f32 v120, v108, v109
    v_mfma_f32_16x16x32_bf16 v[248:251], v[40:43], v[216:219], v[248:251]
    v_cvt_pk_bf16_f32 v121, v110, v111
    v_mfma_f32_16x16x32_bf16 v[248:251], v[44:47], v[220:223], v[248:251]
    v_mfma_f32_16x16x32_bf16 v[248:251], v[48:51], v[224:227], v[248:251]
    v_cvt_pk_bf16_f32 v122, v112, v113
    v_mfma_f32_16x16x32_bf16 v[252:255], v[52:55], v[212:215], 0
    v_cvt_pk_bf16_f32 v123, v114, v115
    v_mfma_f32_16x16x32_bf16 v[252:255], v[56:59], v[216:219], v[252:255]
    v_cvt_pk_bf16_f32 v152, v140, v141
    v_mfma_f32_16x16x32_bf16 v[252:255], v[60:63], v[220:223], v[252:255]
    v_mfma_f32_16x16x32_bf16 v[252:255], v[64:67], v[224:227], v[252:255]
    v_cvt_pk_bf16_f32 v153, v142, v143
    v_cvt_pk_bf16_f32 v70, v244, v245
    v_cvt_pk_bf16_f32 v154, v144, v145
    v_cvt_pk_bf16_f32 v71, v246, v247
    v_cvt_pk_bf16_f32 v155, v146, v147
    v_mfma_f32_16x16x32_bf16 v[164:167], v[32:35], v[88:91], v[164:167]
    v_mfma_f32_16x16x32_bf16 v[96:99], v[16:19], v[88:91], v[96:99]
    v_mfma_f32_16x16x32_bf16 v[180:183], v[48:51], v[120:123], v[180:183]
    v_mfma_f32_16x16x32_bf16 v[128:131], v[16:19], v[120:123], v[128:131]
    v_mfma_f32_16x16x32_bf16 v[196:199], v[64:67], v[152:155], v[196:199]
    v_mfma_f32_16x16x32_bf16 v[160:163], v[16:19], v[152:155], v[160:163]
    s_waitcnt lgkmcnt(0)
    v_mfma_f32_16x16x32_bf16 v[244:247], v[20:23], v[228:231], 0
    ds_read_b128 v[212:215], v4 offset:40960
    v_mfma_f32_16x16x32_bf16 v[244:247], v[24:27], v[232:235], v[244:247]
    ds_read_b128 v[216:219], v4 offset:41984
    v_mfma_f32_16x16x32_bf16 v[244:247], v[28:31], v[236:239], v[244:247]
    ds_read_b128 v[220:223], v4 offset:43008
    v_mul_f32 v164, v164, v168
    v_mul_f32 v180, v180, v184
    v_mfma_f32_16x16x32_bf16 v[244:247], v[32:35], v[240:243], v[244:247]
    v_mul_f32 v196, v196, v200
    ds_read_b128 v[224:227], v4 offset:44032
    v_mul_f32 v165, v165, v169
    v_cvt_pk_bf16_f32 v102, v248, v249
    v_mul_f32 v181, v181, v185
    v_cvt_pk_bf16_f32 v103, v250, v251
    v_mul_f32 v197, v197, v201
    v_mfma_f32_16x16x32_bf16 v[248:251], v[36:39], v[228:231], 0
    v_mul_f32 v166, v166, v170
    v_mfma_f32_16x16x32_bf16 v[248:251], v[40:43], v[232:235], v[248:251]
    v_mul_f32 v182, v182, v186
    v_mfma_f32_16x16x32_bf16 v[248:251], v[44:47], v[236:239], v[248:251]
    v_mul_f32 v198, v198, v202
    v_mul_f32 v167, v167, v171
    v_mfma_f32_16x16x32_bf16 v[248:251], v[48:51], v[240:243], v[248:251]
    v_mul_f32 v183, v183, v187
    v_cvt_pk_bf16_f32 v134, v252, v253
    v_mul_f32 v199, v199, v203
    v_cvt_pk_bf16_f32 v135, v254, v255
    v_fma_f32 v164, -v96, v172, v164
    v_mfma_f32_16x16x32_bf16 v[252:255], v[52:55], v[228:231], 0
    v_fma_f32 v180, -v128, v188, v180
    v_mfma_f32_16x16x32_bf16 v[252:255], v[56:59], v[232:235], v[252:255]
    v_fma_f32 v196, -v160, v204, v196
    v_mfma_f32_16x16x32_bf16 v[252:255], v[60:63], v[236:239], v[252:255]
    v_fma_f32 v165, -v96, v173, v165
    v_mfma_f32_16x16x32_bf16 v[252:255], v[64:67], v[240:243], v[252:255]
    v_fma_f32 v181, -v128, v189, v181
    v_fma_f32 v197, -v160, v205, v197
    v_cvt_pk_bf16_f32 v74, v244, v245
    v_fma_f32 v166, -v96, v174, v166
    v_cvt_pk_bf16_f32 v75, v246, v247
    v_fma_f32 v182, -v128, v190, v182
    s_waitcnt lgkmcnt(0)
    v_fma_f32 v198, -v160, v206, v198
    v_mfma_f32_16x16x32_bf16 v[244:247], v[20:23], v[212:215], 0
    v_fma_f32 v167, -v96, v175, v167
    ds_read_b128 v[228:231], v4 offset:45056
    v_fma_f32 v183, -v128, v191, v183
    v_mfma_f32_16x16x32_bf16 v[244:247], v[24:27], v[216:219], v[244:247]
    v_fma_f32 v199, -v160, v207, v199
    ds_read_b128 v[232:235], v4 offset:46080
    v_mul_f32 v72, s76, v92
    v_mul_f32 v104, s76, v124
    v_mfma_f32_16x16x32_bf16 v[244:247], v[28:31], v[220:223], v[244:247]
    v_mul_f32 v136, s76, v156
    ds_read_b128 v[236:239], v4 offset:47104
    v_max3_f32 v68, v164, v165, v166
    v_mfma_f32_16x16x32_bf16 v[244:247], v[32:35], v[224:227], v[244:247]
    v_max3_f32 v100, v180, v181, v182
    ds_read_b128 v[240:243], v4 offset:48128
    v_max3_f32 v132, v196, v197, v198
    v_cvt_pk_bf16_f32 v106, v248, v249
    v_max_f32 v68, v68, v167
    v_cvt_pk_bf16_f32 v107, v250, v251
    v_max_f32 v100, v100, v183
    v_max_f32 v132, v132, v199
    v_mfma_f32_16x16x32_bf16 v[248:251], v[36:39], v[212:215], 0
    v_mov_b32 v69, v68
    v_mfma_f32_16x16x32_bf16 v[248:251], v[40:43], v[216:219], v[248:251]
    v_mov_b32 v101, v100
    v_mfma_f32_16x16x32_bf16 v[248:251], v[44:47], v[220:223], v[248:251]
    v_mov_b32 v133, v132
    v_mfma_f32_16x16x32_bf16 v[248:251], v[48:51], v[224:227], v[248:251]
    v_permlane16_swap_b32 v68, v69
    v_cvt_pk_bf16_f32 v138, v252, v253
    v_permlane16_swap_b32 v100, v101
    v_cvt_pk_bf16_f32 v139, v254, v255
    v_permlane16_swap_b32 v132, v133
    v_mfma_f32_16x16x32_bf16 v[252:255], v[52:55], v[212:215], 0
    v_max_f32 v68, v68, v69
    v_max_f32 v100, v100, v101
    v_mfma_f32_16x16x32_bf16 v[252:255], v[56:59], v[216:219], v[252:255]
    v_max_f32 v132, v132, v133
    v_mfma_f32_16x16x32_bf16 v[252:255], v[60:63], v[220:223], v[252:255]
    v_mul_f32 v73, v68, v72
    v_mfma_f32_16x16x32_bf16 v[252:255], v[64:67], v[224:227], v[252:255]
    v_mul_f32 v105, v100, v104
    v_cvt_pk_bf16_f32 v78, v244, v245
    v_mul_f32 v137, v132, v136
    v_cvt_pk_bf16_f32 v79, v246, v247
    v_fma_f32 v164, v164, v72, -v73
    s_waitcnt lgkmcnt(0)
    v_fma_f32 v180, v180, v104, -v105
    v_mfma_f32_16x16x32_bf16 v[244:247], v[20:23], v[228:231], 0
    v_fma_f32 v196, v196, v136, -v137
    v_fma_f32 v165, v165, v72, -v73
    ds_read_b128 v[212:215], v4 offset:49152
    v_fma_f32 v181, v181, v104, -v105
    v_mfma_f32_16x16x32_bf16 v[244:247], v[24:27], v[232:235], v[244:247]
    v_fma_f32 v197, v197, v136, -v137
    ds_read_b128 v[216:219], v4 offset:50176
    v_fma_f32 v166, v166, v72, -v73
    v_mfma_f32_16x16x32_bf16 v[244:247], v[28:31], v[236:239], v[244:247]
    v_fma_f32 v182, v182, v104, -v105
    ds_read_b128 v[220:223], v4 offset:51200
    v_fma_f32 v198, v198, v136, -v137
    v_mfma_f32_16x16x32_bf16 v[244:247], v[32:35], v[240:243], v[244:247]
    v_fma_f32 v167, v167, v72, -v73
    ds_read_b128 v[224:227], v4 offset:52224
    v_fma_f32 v183, v183, v104, -v105
    v_fma_f32 v199, v199, v136, -v137
    v_cvt_pk_bf16_f32 v110, v248, v249
    v_exp_f32 v164, v164
    v_cvt_pk_bf16_f32 v111, v250, v251
    v_exp_f32 v180, v180
    v_mfma_f32_16x16x32_bf16 v[248:251], v[36:39], v[228:231], 0
    v_exp_f32 v196, v196
    v_mfma_f32_16x16x32_bf16 v[248:251], v[40:43], v[232:235], v[248:251]
    v_exp_f32 v165, v165
    v_mfma_f32_16x16x32_bf16 v[248:251], v[44:47], v[236:239], v[248:251]
    v_exp_f32 v181, v181
    v_mfma_f32_16x16x32_bf16 v[248:251], v[48:51], v[240:243], v[248:251]
    v_exp_f32 v197, v197
    v_exp_f32 v166, v166
    v_cvt_pk_bf16_f32 v142, v252, v253
    v_exp_f32 v182, v182
    v_cvt_pk_bf16_f32 v143, v254, v255
    v_exp_f32 v198, v198
    v_mfma_f32_16x16x32_bf16 v[252:255], v[52:55], v[228:231], 0
    v_exp_f32 v167, v167
    v_mfma_f32_16x16x32_bf16 v[252:255], v[56:59], v[232:235], v[252:255]
    v_exp_f32 v183, v183
    v_mfma_f32_16x16x32_bf16 v[252:255], v[60:63], v[236:239], v[252:255]
    v_exp_f32 v199, v199
    v_mfma_f32_16x16x32_bf16 v[252:255], v[64:67], v[240:243], v[252:255]
    v_add_f32 v68, v164, v166
    v_cvt_pk_bf16_f32 v82, v244, v245
    v_add_f32 v100, v180, v182
    v_add_f32 v132, v196, v198
    v_cvt_pk_bf16_f32 v83, v246, v247
    v_add_f32 v69, v165, v167
    s_waitcnt lgkmcnt(0)
    v_add_f32 v101, v181, v183
    v_mfma_f32_16x16x32_bf16 v[244:247], v[20:23], v[212:215], 0
    v_add_f32 v133, v197, v199
    ds_read_b128 v[228:231], v4 offset:53248
    v_mul_f32 v164, v164, v168
    v_mfma_f32_16x16x32_bf16 v[244:247], v[24:27], v[216:219], v[244:247]
    v_mul_f32 v180, v180, v184
    ds_read_b128 v[232:235], v4 offset:54272
    v_mul_f32 v196, v196, v200
    v_mfma_f32_16x16x32_bf16 v[244:247], v[28:31], v[220:223], v[244:247]
    v_mul_f32 v165, v165, v169
    v_mul_f32 v181, v181, v185
    ds_read_b128 v[236:239], v4 offset:55296
    v_mul_f32 v197, v197, v201
    v_mfma_f32_16x16x32_bf16 v[244:247], v[32:35], v[224:227], v[244:247]
    v_add_f32 v68, v68, v69
    ds_read_b128 v[240:243], v4 offset:56320
    v_add_f32 v100, v100, v101
    v_cvt_pk_bf16_f32 v114, v248, v249
    v_add_f32 v132, v132, v133
    v_cvt_pk_bf16_f32 v115, v250, v251
    v_mul_f32 v166, v166, v170
    v_mfma_f32_16x16x32_bf16 v[248:251], v[36:39], v[212:215], 0
    v_mul_f32 v182, v182, v186
    v_mfma_f32_16x16x32_bf16 v[248:251], v[40:43], v[216:219], v[248:251]
    v_mul_f32 v198, v198, v202
    v_mul_f32 v167, v167, v171
    v_mfma_f32_16x16x32_bf16 v[248:251], v[44:47], v[220:223], v[248:251]
    v_mul_f32 v183, v183, v187
    v_mfma_f32_16x16x32_bf16 v[248:251], v[48:51], v[224:227], v[248:251]
    v_mul_f32 v199, v199, v203
    v_cvt_pk_bf16_f32 v146, v252, v253
    v_mov_b32 v69, v68
    v_cvt_pk_bf16_f32 v147, v254, v255
    v_mov_b32 v101, v100
    v_mfma_f32_16x16x32_bf16 v[252:255], v[52:55], v[212:215], 0
    v_mov_b32 v133, v132
    v_mfma_f32_16x16x32_bf16 v[252:255], v[56:59], v[216:219], v[252:255]
    v_permlane16_swap_b32 v68, v69
    v_permlane16_swap_b32 v100, v101
    v_mfma_f32_16x16x32_bf16 v[252:255], v[60:63], v[220:223], v[252:255]
    v_permlane16_swap_b32 v132, v133
    v_mfma_f32_16x16x32_bf16 v[252:255], v[64:67], v[224:227], v[252:255]
    v_add_f32 v68, v68, v69
    v_cvt_pk_bf16_f32 v86, v244, v245
    v_add_f32 v100, v100, v101
    v_cvt_pk_bf16_f32 v87, v246, v247
    v_add_f32 v132, v132, v133
    s_waitcnt lgkmcnt(0)
    v_rcp_f32 v68, v68
    v_mfma_f32_16x16x32_bf16 v[244:247], v[20:23], v[228:231], 0
    v_rcp_f32 v100, v100
    ds_read_b128 v[212:215], v4 offset:57344
    v_rcp_f32 v132, v132
    v_mul_f32 v164, v164, v68
    v_mfma_f32_16x16x32_bf16 v[244:247], v[24:27], v[232:235], v[244:247]
    v_mul_f32 v180, v180, v100
    ds_read_b128 v[216:219], v4 offset:58368
    v_mul_f32 v196, v196, v132
    v_mfma_f32_16x16x32_bf16 v[244:247], v[28:31], v[236:239], v[244:247]
    v_mul_f32 v165, v165, v68
    ds_read_b128 v[220:223], v4 offset:59392
    v_mul_f32 v181, v181, v100
    v_mfma_f32_16x16x32_bf16 v[244:247], v[32:35], v[240:243], v[244:247]
    v_mul_f32 v197, v197, v132
    ds_read_b128 v[224:227], v4 offset:60416
    v_mul_f32 v166, v166, v68
    v_cvt_pk_bf16_f32 v118, v248, v249
    v_mul_f32 v182, v182, v100
    v_mul_f32 v198, v198, v132
    v_cvt_pk_bf16_f32 v119, v250, v251
    v_mul_f32 v167, v167, v68
    v_mfma_f32_16x16x32_bf16 v[248:251], v[36:39], v[228:231], 0
    v_mul_f32 v183, v183, v100
    v_mfma_f32_16x16x32_bf16 v[248:251], v[40:43], v[232:235], v[248:251]
    v_mul_f32 v199, v199, v132
    v_mfma_f32_16x16x32_bf16 v[248:251], v[44:47], v[236:239], v[248:251]
    v_cvt_pk_bf16_f32 v68, v164, v165
    v_mfma_f32_16x16x32_bf16 v[248:251], v[48:51], v[240:243], v[248:251]
    v_cvt_pk_bf16_f32 v100, v180, v181
    v_cvt_pk_bf16_f32 v150, v252, v253
    v_cvt_pk_bf16_f32 v132, v196, v197
    v_cvt_pk_bf16_f32 v151, v254, v255
    v_cvt_pk_bf16_f32 v69, v166, v167
    v_cvt_pk_bf16_f32 v101, v182, v183
    v_mfma_f32_16x16x32_bf16 v[252:255], v[52:55], v[228:231], 0
    v_cvt_pk_bf16_f32 v133, v198, v199
    v_mfma_f32_16x16x32_bf16 v[252:255], v[56:59], v[232:235], v[252:255]
    v_cndmask_b32 v178, 0, v68, s[66:67]
    v_mfma_f32_16x16x32_bf16 v[252:255], v[60:63], v[236:239], v[252:255]
    v_cndmask_b32 v194, 0, v100, s[66:67]
    v_mfma_f32_16x16x32_bf16 v[252:255], v[64:67], v[240:243], v[252:255]
    v_cndmask_b32 v210, 0, v132, s[66:67]
    v_cvt_pk_bf16_f32 v90, v244, v245
    v_cndmask_b32 v179, 0, v69, s[66:67]
    v_cvt_pk_bf16_f32 v91, v246, v247
    v_cndmask_b32 v195, 0, v101, s[66:67]
    v_cndmask_b32 v211, 0, v133, s[66:67]
    s_waitcnt lgkmcnt(0)
    v_mfma_f32_16x16x32_bf16 v[244:247], v[20:23], v[212:215], 0
    ds_read_b64_tr_b16 v[68:69], v3 offset:0
    ds_read_b128 v[228:231], v4 offset:61440
    v_mfma_f32_16x16x32_bf16 v[244:247], v[24:27], v[216:219], v[244:247]
    ds_read_b64_tr_b16 v[100:101], v3 offset:128
    ds_read_b128 v[232:235], v4 offset:62464
    v_mfma_f32_16x16x32_bf16 v[244:247], v[28:31], v[220:223], v[244:247]
    ds_read_b64_tr_b16 v[132:133], v3 offset:256
    ds_read_b128 v[236:239], v4 offset:63488
    v_mfma_f32_16x16x32_bf16 v[244:247], v[32:35], v[224:227], v[244:247]
    ds_read_b64_tr_b16 v[72:73], v3 offset:320
    ds_read_b128 v[240:243], v4 offset:64512
    v_cvt_pk_bf16_f32 v122, v248, v249
    ds_read_b64_tr_b16 v[104:105], v3 offset:448
    v_cvt_pk_bf16_f32 v123, v250, v251
    v_mfma_f32_16x16x32_bf16 v[248:251], v[36:39], v[212:215], 0
    ds_read_b64_tr_b16 v[136:137], v3 offset:576
    v_mfma_f32_16x16x32_bf16 v[248:251], v[40:43], v[216:219], v[248:251]
    v_mfma_f32_16x16x32_bf16 v[248:251], v[44:47], v[220:223], v[248:251]
    ds_read_b64_tr_b16 v[76:77], v3 offset:2560
    v_mfma_f32_16x16x32_bf16 v[248:251], v[48:51], v[224:227], v[248:251]
    v_cvt_pk_bf16_f32 v154, v252, v253
    ds_read_b64_tr_b16 v[108:109], v3 offset:2688
    v_cvt_pk_bf16_f32 v155, v254, v255
    v_mfma_f32_16x16x32_bf16 v[252:255], v[52:55], v[212:215], 0
    ds_read_b64_tr_b16 v[140:141], v3 offset:2816
    v_mfma_f32_16x16x32_bf16 v[252:255], v[56:59], v[216:219], v[252:255]
    v_mfma_f32_16x16x32_bf16 v[252:255], v[60:63], v[220:223], v[252:255]
    ds_read_b64_tr_b16 v[80:81], v3 offset:2880
    v_mfma_f32_16x16x32_bf16 v[252:255], v[64:67], v[224:227], v[252:255]
    v_cvt_pk_bf16_f32 v94, v244, v245
    ds_read_b64_tr_b16 v[112:113], v3 offset:3008
    v_cvt_pk_bf16_f32 v95, v246, v247
    s_waitcnt lgkmcnt(7)
    ds_read_b64_tr_b16 v[144:145], v3 offset:3136
    v_mfma_f32_16x16x32_bf16 v[244:247], v[20:23], v[228:231], 0
    v_add_u32 v4, 65536, v4
    ds_read_b64_tr_b16 v[84:85], v3 offset:5120
    v_mfma_f32_16x16x32_bf16 v[244:247], v[24:27], v[232:235], v[244:247]
    ds_read_b128 v[212:215], v4 offset:0
    ds_read_b64_tr_b16 v[116:117], v3 offset:5248
    v_mfma_f32_16x16x32_bf16 v[244:247], v[28:31], v[236:239], v[244:247]
    ds_read_b128 v[216:219], v4 offset:1024
    ds_read_b64_tr_b16 v[148:149], v3 offset:5376
    v_mfma_f32_16x16x32_bf16 v[244:247], v[32:35], v[240:243], v[244:247]
    ds_read_b128 v[220:223], v4 offset:2048
    ds_read_b64_tr_b16 v[88:89], v3 offset:5440
    v_cvt_pk_bf16_f32 v126, v248, v249
    ds_read_b128 v[224:227], v4 offset:3072
    ds_read_b64_tr_b16 v[120:121], v3 offset:5568
    v_cvt_pk_bf16_f32 v127, v250, v251
    v_mfma_f32_16x16x32_bf16 v[248:251], v[36:39], v[228:231], 0
    ds_read_b64_tr_b16 v[152:153], v3 offset:5696
    v_mfma_f32_16x16x32_bf16 v[248:251], v[40:43], v[232:235], v[248:251]
    v_mfma_f32_16x16x32_bf16 v[248:251], v[44:47], v[236:239], v[248:251]
    ds_read_b64_tr_b16 v[92:93], v3 offset:7680
    v_mfma_f32_16x16x32_bf16 v[248:251], v[48:51], v[240:243], v[248:251]
    v_cvt_pk_bf16_f32 v158, v252, v253
    ds_read_b64_tr_b16 v[124:125], v3 offset:7808
    v_cvt_pk_bf16_f32 v159, v254, v255
    v_mfma_f32_16x16x32_bf16 v[252:255], v[52:55], v[228:231], 0
    ds_read_b64_tr_b16 v[156:157], v3 offset:7936
    v_mfma_f32_16x16x32_bf16 v[252:255], v[56:59], v[232:235], v[252:255]
    v_mfma_f32_16x16x32_bf16 v[252:255], v[60:63], v[236:239], v[252:255]
    ds_read_b64_tr_b16 v[96:97], v3 offset:8000
    v_mfma_f32_16x16x32_bf16 v[252:255], v[64:67], v[240:243], v[252:255]
    v_cvt_pk_bf16_f32 v98, v244, v245
    ds_read_b64_tr_b16 v[128:129], v3 offset:8128
    v_cvt_pk_bf16_f32 v99, v246, v247
    ds_read_b64_tr_b16 v[160:161], v3 offset:8256
    v_cvt_pk_bf16_f32 v130, v248, v249
    v_cvt_pk_bf16_f32 v131, v250, v251
    s_nop 1
    v_cvt_pk_bf16_f32 v162, v252, v253
    v_cvt_pk_bf16_f32 v163, v254, v255
    v_mfma_f32_16x16x16_bf16 v[168:171], v[178:179], v[176:177], 0
    v_mfma_f32_16x16x16_bf16 v[184:187], v[194:195], v[192:193], 0
    v_mfma_f32_16x16x16_bf16 v[200:203], v[210:211], v[208:209], 0
    v_mfma_f32_16x16x32_bf16 v[244:247], v[68:71], v[176:179], 0
    v_mfma_f32_16x16x32_bf16 v[248:251], v[100:103], v[192:195], 0
    v_mfma_f32_16x16x32_bf16 v[252:255], v[132:135], v[208:211], 0
    v_mfma_f32_16x16x32_bf16 v[228:231], v[72:75], v[176:179], 0
    s_waitcnt lgkmcnt(15)
    v_mfma_f32_16x16x32_bf16 v[232:235], v[104:107], v[192:195], 0
    s_nop 2
    v_cvt_pk_bf16_f32 v20, v244, v245
    v_cvt_pk_bf16_f32 v21, v246, v247
    v_mfma_f32_16x16x32_bf16 v[236:239], v[136:139], v[208:211], 0
    v_cvt_pk_bf16_f32 v36, v248, v249
    v_cvt_pk_bf16_f32 v37, v250, v251
    v_mfma_f32_16x16x32_bf16 v[240:243], v[76:79], v[176:179], 0
    v_cvt_pk_bf16_f32 v52, v252, v253
    v_cvt_pk_bf16_f32 v53, v254, v255
    v_mfma_f32_16x16x32_bf16 v[244:247], v[108:111], v[192:195], 0
    v_cvt_pk_bf16_f32 v22, v228, v229
    v_cvt_pk_bf16_f32 v23, v230, v231
    v_mfma_f32_16x16x32_bf16 v[248:251], v[140:143], v[208:211], 0
    v_cvt_pk_bf16_f32 v38, v232, v233
    v_cvt_pk_bf16_f32 v39, v234, v235
    v_mfma_f32_16x16x32_bf16 v[252:255], v[80:83], v[176:179], 0
    v_cvt_pk_bf16_f32 v54, v236, v237
    v_cvt_pk_bf16_f32 v55, v238, v239
    v_mfma_f32_16x16x32_bf16 v[228:231], v[112:115], v[192:195], 0
    v_cvt_pk_bf16_f32 v24, v240, v241
    v_cvt_pk_bf16_f32 v25, v242, v243
    v_mfma_f32_16x16x32_bf16 v[232:235], v[144:147], v[208:211], 0
    v_cvt_pk_bf16_f32 v40, v244, v245
    v_cvt_pk_bf16_f32 v41, v246, v247
    v_mfma_f32_16x16x32_bf16 v[236:239], v[84:87], v[176:179], 0
    v_cvt_pk_bf16_f32 v56, v248, v249
    v_cvt_pk_bf16_f32 v57, v250, v251
    s_waitcnt lgkmcnt(13)
    v_mfma_f32_16x16x32_bf16 v[240:243], v[116:119], v[192:195], 0
    v_cvt_pk_bf16_f32 v26, v252, v253
    v_cvt_pk_bf16_f32 v27, v254, v255
    s_waitcnt lgkmcnt(11)
    v_mfma_f32_16x16x32_bf16 v[244:247], v[148:151], v[208:211], 0
    v_cvt_pk_bf16_f32 v42, v228, v229
    v_cvt_pk_bf16_f32 v43, v230, v231
    s_waitcnt lgkmcnt(9)
    v_mfma_f32_16x16x32_bf16 v[248:251], v[88:91], v[176:179], 0
    v_cvt_pk_bf16_f32 v58, v232, v233
    v_cvt_pk_bf16_f32 v59, v234, v235
    s_waitcnt lgkmcnt(7)
    v_mfma_f32_16x16x32_bf16 v[252:255], v[120:123], v[192:195], 0
    v_cvt_pk_bf16_f32 v28, v236, v237
    v_cvt_pk_bf16_f32 v29, v238, v239
    s_waitcnt lgkmcnt(6)
    v_mfma_f32_16x16x32_bf16 v[228:231], v[152:155], v[208:211], 0
    v_cvt_pk_bf16_f32 v44, v240, v241
    v_cvt_pk_bf16_f32 v45, v242, v243
    s_waitcnt lgkmcnt(5)
    v_mfma_f32_16x16x32_bf16 v[232:235], v[92:95], v[176:179], 0
    v_cvt_pk_bf16_f32 v60, v244, v245
    v_cvt_pk_bf16_f32 v61, v246, v247
    s_waitcnt lgkmcnt(4)
    v_mfma_f32_16x16x32_bf16 v[236:239], v[124:127], v[192:195], 0
    v_cvt_pk_bf16_f32 v30, v248, v249
    v_cvt_pk_bf16_f32 v31, v250, v251
    s_waitcnt lgkmcnt(3)
    v_mfma_f32_16x16x32_bf16 v[240:243], v[156:159], v[208:211], 0
    v_cvt_pk_bf16_f32 v46, v252, v253
    v_cvt_pk_bf16_f32 v47, v254, v255
    s_waitcnt lgkmcnt(2)
    v_mfma_f32_16x16x32_bf16 v[244:247], v[96:99], v[176:179], 0
    v_cvt_pk_bf16_f32 v62, v228, v229
    v_cvt_pk_bf16_f32 v63, v230, v231
    s_waitcnt lgkmcnt(1)
    v_mfma_f32_16x16x32_bf16 v[248:251], v[128:131], v[192:195], 0
    v_cvt_pk_bf16_f32 v32, v232, v233
    v_cvt_pk_bf16_f32 v33, v234, v235
    s_waitcnt lgkmcnt(0)
    v_mfma_f32_16x16x32_bf16 v[252:255], v[160:163], v[208:211], 0
    v_cvt_pk_bf16_f32 v48, v236, v237
    v_cvt_pk_bf16_f32 v49, v238, v239
    v_cvt_pk_bf16_f32 v64, v240, v241
    v_cvt_pk_bf16_f32 v65, v242, v243
    v_cvt_pk_bf16_f32 v34, v244, v245
    v_cvt_pk_bf16_f32 v35, v246, v247
    v_cvt_pk_bf16_f32 v50, v248, v249
    v_cvt_pk_bf16_f32 v51, v250, v251
    v_cvt_pk_bf16_f32 v66, v252, v253
    v_cvt_pk_bf16_f32 v67, v254, v255
    v_cvt_pk_bf16_f32 v168, v168, v169
    v_cvt_pk_bf16_f32 v169, v170, v171
    v_cvt_pk_bf16_f32 v184, v184, v185
    v_cvt_pk_bf16_f32 v185, v186, v187
    v_cvt_pk_bf16_f32 v200, v200, v201
    v_cvt_pk_bf16_f32 v201, v202, v203
    v_mfma_f32_16x16x32_bf16 v[164:167], v[20:23], v[20:23], 0
    v_mfma_f32_16x16x32_bf16 v[164:167], v[24:27], v[24:27], v[164:167]
    v_mfma_f32_16x16x32_bf16 v[164:167], v[28:31], v[28:31], v[164:167]
    v_mfma_f32_16x16x32_bf16 v[164:167], v[32:35], v[32:35], v[164:167]
    v_mfma_f32_16x16x32_bf16 v[172:175], v[212:215], v[20:23], 0
    v_mfma_f32_16x16x32_bf16 v[172:175], v[216:219], v[24:27], v[172:175]
    v_mfma_f32_16x16x32_bf16 v[172:175], v[220:223], v[28:31], v[172:175]
    v_mfma_f32_16x16x32_bf16 v[172:175], v[224:227], v[32:35], v[172:175]
    v_mfma_f32_16x16x32_bf16 v[180:183], v[36:39], v[36:39], 0
    v_mfma_f32_16x16x32_bf16 v[180:183], v[40:43], v[40:43], v[180:183]
    v_mfma_f32_16x16x32_bf16 v[180:183], v[44:47], v[44:47], v[180:183]
    v_mfma_f32_16x16x32_bf16 v[180:183], v[48:51], v[48:51], v[180:183]
    v_mfma_f32_16x16x32_bf16 v[188:191], v[212:215], v[36:39], 0
    v_mfma_f32_16x16x32_bf16 v[188:191], v[216:219], v[40:43], v[188:191]
    v_mfma_f32_16x16x32_bf16 v[188:191], v[220:223], v[44:47], v[188:191]
    v_mfma_f32_16x16x32_bf16 v[188:191], v[224:227], v[48:51], v[188:191]
    v_mfma_f32_16x16x32_bf16 v[196:199], v[52:55], v[52:55], 0
    v_mfma_f32_16x16x32_bf16 v[196:199], v[56:59], v[56:59], v[196:199]
    v_mfma_f32_16x16x32_bf16 v[196:199], v[60:63], v[60:63], v[196:199]
    v_mfma_f32_16x16x32_bf16 v[196:199], v[64:67], v[64:67], v[196:199]
    v_mfma_f32_16x16x32_bf16 v[204:207], v[212:215], v[52:55], 0
    v_mfma_f32_16x16x32_bf16 v[204:207], v[216:219], v[56:59], v[204:207]
    v_mfma_f32_16x16x32_bf16 v[204:207], v[220:223], v[60:63], v[204:207]
    v_mfma_f32_16x16x32_bf16 v[204:207], v[224:227], v[64:67], v[204:207]
    v_cndmask_b32 v164, v164, v165, s[60:61]
    v_cndmask_b32 v180, v180, v181, s[60:61]
    s_nop 1
    v_cndmask_b32 v196, v196, v197, s[60:61]
    v_mul_f32 v172, s74, v172
    v_mul_f32 v188, s74, v188
    s_nop 0
    v_mul_f32 v204, s74, v204
    v_cndmask_b32 v164, v164, v166, s[62:63]
    v_cndmask_b32 v180, v180, v182, s[62:63]
    v_cndmask_b32 v196, v196, v198, s[62:63]
    v_mul_f32 v174, v172, v172
    v_mul_f32 v190, v188, v188
    v_mul_f32 v206, v204, v204
    v_cndmask_b32 v164, v164, v167, s[64:65]
    v_cndmask_b32 v180, v180, v183, s[64:65]
    v_cndmask_b32 v196, v196, v199, s[64:65]
    v_fma_f32 v164, v164, s74, -v174
    v_fma_f32 v180, v180, s74, -v190
    v_fma_f32 v196, v196, s74, -v206
    v_fma_f32 v173, -v172, v10, v173
    v_fma_f32 v189, -v188, v10, v189
    v_fma_f32 v205, -v204, v10, v205
    v_max_f32 v164, 0, v164
    v_max_f32 v180, 0, v180
    v_max_f32 v196, 0, v196
    v_add_f32 v164, s75, v164
    v_add_f32 v180, s75, v180
    v_add_f32 v196, s75, v196
    v_rsq_f32 v164, v164
    v_rsq_f32 v180, v180
    v_rsq_f32 v196, v196
    v_mul_f32 v173, s77, v173
    v_mul_f32 v189, s77, v189
    v_mul_f32 v205, s77, v205
    v_mul_f32 v164, v164, v173
    v_mul_f32 v180, v180, v189
    v_mul_f32 v196, v196, v205
    ds_write_b32 v5, v164 offset:0
    ds_write_b32 v5, v180 offset:256
    ds_write_b32 v5, v196 offset:512
    ds_read_b128 v[164:167], v7 offset:0
    ds_read_b128 v[180:183], v7 offset:256
    ds_read_b128 v[196:199], v7 offset:512
    ds_read_b128 v[172:175], v8 offset:0
    ds_read_b128 v[188:191], v8 offset:256
    ds_read_b128 v[204:207], v8 offset:512
    s_waitcnt lgkmcnt(5)
    v_max3_f32 v170, v164, v165, v166
    s_waitcnt lgkmcnt(4)
    v_max3_f32 v186, v180, v181, v182
    s_waitcnt lgkmcnt(3)
    v_max3_f32 v202, v196, v197, v198
    s_waitcnt lgkmcnt(2)
    v_max3_f32 v171, v172, v173, v174
    s_waitcnt lgkmcnt(1)
    v_max3_f32 v187, v188, v189, v190
    s_waitcnt lgkmcnt(0)
    v_max3_f32 v203, v204, v205, v206
    v_max3_f32 v170, v170, v167, v175
    v_max3_f32 v186, v186, v183, v191
    v_max3_f32 v202, v202, v199, v207
    v_max_f32 v170, v170, v171
    v_max_f32 v186, v186, v187
    v_max_f32 v202, v202, v203
    v_pk_add_f32 v[164:165], v[164:165], v[170:171] op_sel_hi:[1,0] neg_lo:[0,1] neg_hi:[0,1]
    v_pk_add_f32 v[180:181], v[180:181], v[186:187] op_sel_hi:[1,0] neg_lo:[0,1] neg_hi:[0,1]
    v_pk_add_f32 v[196:197], v[196:197], v[202:203] op_sel_hi:[1,0] neg_lo:[0,1] neg_hi:[0,1]
    v_pk_add_f32 v[166:167], v[166:167], v[170:171] op_sel_hi:[1,0] neg_lo:[0,1] neg_hi:[0,1]
    v_pk_add_f32 v[182:183], v[182:183], v[186:187] op_sel_hi:[1,0] neg_lo:[0,1] neg_hi:[0,1]
    v_pk_add_f32 v[198:199], v[198:199], v[202:203] op_sel_hi:[1,0] neg_lo:[0,1] neg_hi:[0,1]
    v_exp_f32 v164, v164
    v_exp_f32 v180, v180
    v_exp_f32 v196, v196
    v_exp_f32 v165, v165
    v_exp_f32 v181, v181
    v_exp_f32 v197, v197
    v_exp_f32 v166, v166
    v_exp_f32 v182, v182
    v_exp_f32 v198, v198
    v_exp_f32 v167, v167
    v_exp_f32 v183, v183
    v_exp_f32 v199, v199
    v_pk_add_f32 v[170:171], v[164:165], v[166:167]
    v_pk_add_f32 v[186:187], v[180:181], v[182:183]
    v_pk_add_f32 v[202:203], v[196:197], v[198:199]
    v_add_f32 v170, v170, v171
    v_add_f32 v186, v186, v187
    v_add_f32 v202, v202, v203
    v_mov_b32 v171, v170
    v_mov_b32 v187, v186
    v_mov_b32 v203, v202
    v_permlane16_swap_b32 v170, v171
    v_permlane16_swap_b32 v186, v187
    v_permlane16_swap_b32 v202, v203
    v_add_f32 v170, v170, v171
    v_add_f32 v186, v186, v187
    v_add_f32 v202, v202, v203
    v_rcp_f32 v170, v170
    v_rcp_f32 v186, v186
    v_rcp_f32 v202, v202
    v_pk_mul_f32 v[164:165], v[164:165], v[170:171] op_sel_hi:[1,0]
    v_pk_mul_f32 v[180:181], v[180:181], v[186:187] op_sel_hi:[1,0]
    v_pk_mul_f32 v[196:197], v[196:197], v[202:203] op_sel_hi:[1,0]
    v_pk_mul_f32 v[166:167], v[166:167], v[170:171] op_sel_hi:[1,0]
    v_pk_mul_f32 v[182:183], v[182:183], v[186:187] op_sel_hi:[1,0]
    v_pk_mul_f32 v[198:199], v[198:199], v[202:203] op_sel_hi:[1,0]
    v_cvt_pk_bf16_f32 v170, v164, v165
    v_cvt_pk_bf16_f32 v186, v180, v181
    v_cvt_pk_bf16_f32 v202, v196, v197
    v_cvt_pk_bf16_f32 v171, v166, v167
    v_cvt_pk_bf16_f32 v187, v182, v183
    v_cvt_pk_bf16_f32 v203, v198, v199
    v_cndmask_b32 v172, 0, v170, s[68:69]
    v_cndmask_b32 v188, 0, v186, s[70:71]
    v_cndmask_b32 v204, 0, v202, s[72:73]
    v_cndmask_b32 v173, 0, v171, s[68:69]
    v_cndmask_b32 v189, 0, v187, s[70:71]
    v_cndmask_b32 v205, 0, v203, s[72:73]
    v_mfma_f32_16x16x16_bf16 v[164:167], v[168:169], v[172:173], 0
    v_mfma_f32_16x16x16_bf16 v[180:183], v[184:185], v[188:189], 0
    v_mfma_f32_16x16x16_bf16 v[196:199], v[200:201], v[204:205], 0
    s_nop 5
    v_cvt_pk_bf16_f32 v174, v164, v165
    v_cvt_pk_bf16_f32 v175, v166, v167
    v_cvt_pk_bf16_f32 v190, v180, v181
    v_cvt_pk_bf16_f32 v191, v182, v183
    v_cvt_pk_bf16_f32 v206, v196, v197
    v_cvt_pk_bf16_f32 v207, v198, v199
    v_mfma_f32_16x16x32_bf16 v[212:215], v[68:71], v[172:175], 0
    v_mfma_f32_16x16x32_bf16 v[216:219], v[72:75], v[172:175], 0
    v_mfma_f32_16x16x32_bf16 v[220:223], v[76:79], v[172:175], 0
    v_mfma_f32_16x16x32_bf16 v[224:227], v[80:83], v[172:175], 0
    v_mfma_f32_16x16x32_bf16 v[228:231], v[84:87], v[172:175], 0
    v_mfma_f32_16x16x32_bf16 v[232:235], v[88:91], v[172:175], 0
    v_mfma_f32_16x16x32_bf16 v[236:239], v[92:95], v[172:175], 0
    v_mfma_f32_16x16x32_bf16 v[240:243], v[96:99], v[172:175], 0
    v_mfma_f32_16x16x32_bf16 v[212:215], v[100:103], v[188:191], v[212:215]
    v_mfma_f32_16x16x32_bf16 v[216:219], v[104:107], v[188:191], v[216:219]
    v_mfma_f32_16x16x32_bf16 v[220:223], v[108:111], v[188:191], v[220:223]
    v_mfma_f32_16x16x32_bf16 v[224:227], v[112:115], v[188:191], v[224:227]
    v_mfma_f32_16x16x32_bf16 v[228:231], v[116:119], v[188:191], v[228:231]
    v_mfma_f32_16x16x32_bf16 v[232:235], v[120:123], v[188:191], v[232:235]
    v_mfma_f32_16x16x32_bf16 v[236:239], v[124:127], v[188:191], v[236:239]
    v_mfma_f32_16x16x32_bf16 v[240:243], v[128:131], v[188:191], v[240:243]
    v_mfma_f32_16x16x32_bf16 v[212:215], v[132:135], v[204:207], v[212:215]
    v_mfma_f32_16x16x32_bf16 v[216:219], v[136:139], v[204:207], v[216:219]
    v_mfma_f32_16x16x32_bf16 v[220:223], v[140:143], v[204:207], v[220:223]
    v_mfma_f32_16x16x32_bf16 v[224:227], v[144:147], v[204:207], v[224:227]
    v_mfma_f32_16x16x32_bf16 v[228:231], v[148:151], v[204:207], v[228:231]
    v_mfma_f32_16x16x32_bf16 v[232:235], v[152:155], v[204:207], v[232:235]
    v_mfma_f32_16x16x32_bf16 v[236:239], v[156:159], v[204:207], v[236:239]
    v_mfma_f32_16x16x32_bf16 v[240:243], v[160:163], v[204:207], v[240:243]
    s_nop 0
    v_cvt_pk_bf16_f32 v20, v212, v213
    v_cvt_pk_bf16_f32 v21, v214, v215
    v_cvt_pk_bf16_f32 v22, v216, v217
    v_cvt_pk_bf16_f32 v23, v218, v219
    buffer_store_dwordx4 v[20:23], v9, s[28:31], 0 offen offset:0
    v_cvt_pk_bf16_f32 v24, v220, v221
    v_cvt_pk_bf16_f32 v25, v222, v223
    v_cvt_pk_bf16_f32 v26, v224, v225
    v_cvt_pk_bf16_f32 v27, v226, v227
    buffer_store_dwordx4 v[24:27], v9, s[28:31], 0 offen offset:64
    v_cvt_pk_bf16_f32 v28, v228, v229
    v_cvt_pk_bf16_f32 v29, v230, v231
    v_cvt_pk_bf16_f32 v30, v232, v233
    v_cvt_pk_bf16_f32 v31, v234, v235
    buffer_store_dwordx4 v[28:31], v9, s[28:31], 0 offen offset:128
    v_cvt_pk_bf16_f32 v32, v236, v237
    v_cvt_pk_bf16_f32 v33, v238, v239
    v_cvt_pk_bf16_f32 v34, v240, v241
    v_cvt_pk_bf16_f32 v35, v242, v243
    buffer_store_dwordx4 v[32:35], v9, s[28:31], 0 offen offset:192
    s_branch L_tf_fin
L_pl_608:
buffer_load_dwordx2 v[92:93], v39, s[4:7], s40 offen sc1
s_add_u32 s57, s57, 1
s_cmp_gt_u32 s57, 4194304
s_cbranch_scc1 L_end
s_waitcnt vmcnt(0)
v_lshl_add_u64 v[40:41], v[92:93], 0, s[58:59]
v_cmp_le_u64 vcc, 64, v[40:41]
s_cbranch_vccz L_pn_610
s_sleep 4
s_branch L_pl_608
L_pn_610:
s_branch L_pd_609
L_tc_606:
s_sub_u32 s58, 0, s87
s_mov_b32 exec_hi, 0
v_lshl_add_u64 v[40:41], v[92:93], 0, s[58:59]
v_cmp_le_u64 vcc, 64, v[40:41]
s_cbranch_vccnz L_pl_608
L_pd_609:
s_mov_b64 exec, -1
s_branch L_tcr_607
L_x7again:
s_sleep 4
buffer_load_dwordx4 v[76:79], v47, s[4:7], s82 offen sc1
s_add_u32 s57, s57, 1
s_cmp_gt_u32 s57, 4194304
s_cbranch_scc1 L_end
s_waitcnt vmcnt(0)
v_xor_b32 v40, v78, v23
v_xor_b32 v41, v79, v23
v_or_b32 v40, v40, v41
v_cmp_ne_u32 vcc, 0, v40
s_cbranch_vccnz L_x7again
s_branch L_x7ok
    s_nop 0
L_tf_two:
    ds_read_b64 v[20:21], v2 offset:0
    ds_read_b64 v[22:23], v2 offset:320
    ds_read_b64 v[24:25], v2 offset:2560
    ds_read_b64 v[26:27], v2 offset:2880
    ds_read_b64 v[28:29], v2 offset:5120
    ds_read_b64 v[30:31], v2 offset:5440
    ds_read_b64 v[32:33], v2 offset:7680
    ds_read_b64 v[34:35], v2 offset:8000
    ds_read_b64 v[36:37], v2 offset:128
    ds_read_b64 v[38:39], v2 offset:448
    ds_read_b64 v[40:41], v2 offset:2688
    ds_read_b64 v[42:43], v2 offset:3008
    ds_read_b64 v[44:45], v2 offset:5248
    ds_read_b64 v[46:47], v2 offset:5568
    ds_read_b64 v[48:49], v2 offset:7808
    ds_read_b64 v[50:51], v2 offset:8128
    ds_read_b128 v[212:215], v4 offset:0
    ds_read_b128 v[216:219], v4 offset:1024
    ds_read_b128 v[220:223], v4 offset:2048
    ds_read_b128 v[224:227], v4 offset:3072
    s_waitcnt lgkmcnt(15)
    v_mfma_f32_16x16x32_bf16 v[76:79], v[20:23], v[20:23], 0
    v_mfma_f32_16x16x32_bf16 v[76:79], v[24:27], v[24:27], v[76:79]
    s_waitcnt lgkmcnt(14)
    v_mfma_f32_16x16x32_bf16 v[76:79], v[28:31], v[28:31], v[76:79]
    s_waitcnt lgkmcnt(12)
    v_mfma_f32_16x16x32_bf16 v[76:79], v[32:35], v[32:35], v[76:79]
    v_mfma_f32_16x16x32_bf16 v[80:83], v[16:19], v[20:23], 0
    v_mfma_f32_16x16x32_bf16 v[80:83], v[16:19], v[24:27], v[80:83]
    v_mfma_f32_16x16x32_bf16 v[80:83], v[16:19], v[28:31], v[80:83]
    v_mfma_f32_16x16x32_bf16 v[80:83], v[16:19], v[32:35], v[80:83]
    s_waitcnt lgkmcnt(10)
    v_mfma_f32_16x16x32_bf16 v[108:111], v[36:39], v[36:39], 0
    s_waitcnt lgkmcnt(8)
    v_mfma_f32_16x16x32_bf16 v[108:111], v[40:43], v[40:43], v[108:111]
    s_waitcnt lgkmcnt(6)
    v_mfma_f32_16x16x32_bf16 v[108:111], v[44:47], v[44:47], v[108:111]
    s_waitcnt lgkmcnt(4)
    v_mfma_f32_16x16x32_bf16 v[108:111], v[48:51], v[48:51], v[108:111]
    v_mfma_f32_16x16x32_bf16 v[112:115], v[16:19], v[36:39], 0
    v_mfma_f32_16x16x32_bf16 v[112:115], v[16:19], v[40:43], v[112:115]
    v_mfma_f32_16x16x32_bf16 v[112:115], v[16:19], v[44:47], v[112:115]
    v_mfma_f32_16x16x32_bf16 v[112:115], v[16:19], v[48:51], v[112:115]
    s_waitcnt lgkmcnt(0)
    v_cndmask_b32 v76, v76, v77, s[60:61]
    v_mfma_f32_16x16x32_bf16 v[68:71], v[212:215], v[20:23], 0
    v_mul_f32 v80, s74, v80
    ds_read_b128 v[228:231], v4 offset:4096
    v_cndmask_b32 v76, v76, v78, s[62:63]
    v_mfma_f32_16x16x32_bf16 v[68:71], v[216:219], v[24:27], v[68:71]
    v_mul_f32 v81, v80, v80
    ds_read_b128 v[232:235], v4 offset:5120
    v_cndmask_b32 v76, v76, v79, s[64:65]
    v_mfma_f32_16x16x32_bf16 v[68:71], v[220:223], v[28:31], v[68:71]
    v_fma_f32 v76, v76, s74, -v81
    ds_read_b128 v[236:239], v4 offset:6144
    v_max_f32 v76, 0, v76
    v_mfma_f32_16x16x32_bf16 v[68:71], v[224:227], v[32:35], v[68:71]
    v_add_f32 v76, s75, v76
    ds_read_b128 v[240:243], v4 offset:7168
    v_rsq_f32 v76, v76
    v_mfma_f32_16x16x32_bf16 v[100:103], v[212:215], v[36:39], 0
    v_mul_f32 v80, v80, v76
    v_mfma_f32_16x16x32_bf16 v[100:103], v[216:219], v[40:43], v[100:103]
    ds_write2_b32 v5, v76, v80 offset0:0 offset1:16
    v_mfma_f32_16x16x32_bf16 v[100:103], v[220:223], v[44:47], v[100:103]
    ds_read_b32 v92, v6 offset:0
    v_mfma_f32_16x16x32_bf16 v[100:103], v[224:227], v[48:51], v[100:103]
    ds_read_b128 v[168:171], v7 offset:0
    ds_read_b128 v[172:175], v7 offset:64
    s_waitcnt lgkmcnt(4)
    v_cndmask_b32 v108, v108, v109, s[60:61]
    v_mfma_f32_16x16x32_bf16 v[72:75], v[228:231], v[20:23], 0
    v_mul_f32 v112, s74, v112
    ds_read_b128 v[212:215], v4 offset:8192
    v_cndmask_b32 v108, v108, v110, s[62:63]
    v_mfma_f32_16x16x32_bf16 v[72:75], v[232:235], v[24:27], v[72:75]
    v_mul_f32 v113, v112, v112
    ds_read_b128 v[216:219], v4 offset:9216
    v_cndmask_b32 v108, v108, v111, s[64:65]
    v_mfma_f32_16x16x32_bf16 v[72:75], v[236:239], v[28:31], v[72:75]
    v_fma_f32 v108, v108, s74, -v113
    ds_read_b128 v[220:223], v4 offset:10240
    v_max_f32 v108, 0, v108
    v_mfma_f32_16x16x32_bf16 v[72:75], v[240:243], v[32:35], v[72:75]
    v_add_f32 v108, s75, v108
    ds_read_b128 v[224:227], v4 offset:11264
    v_rsq_f32 v108, v108
    v_mfma_f32_16x16x32_bf16 v[104:107], v[228:231], v[36:39], 0
    v_mul_f32 v112, v112, v108
    v_mfma_f32_16x16x32_bf16 v[104:107], v[232:235], v[40:43], v[104:107]
    ds_write2_b32 v5, v108, v112 offset0:64 offset1:80
    v_mfma_f32_16x16x32_bf16 v[104:107], v[236:239], v[44:47], v[104:107]
    ds_read_b32 v124, v6 offset:256
    v_mfma_f32_16x16x32_bf16 v[104:107], v[240:243], v[48:51], v[104:107]
    ds_read_b128 v[184:187], v7 offset:256
    ds_read_b128 v[188:191], v7 offset:320
    s_waitcnt lgkmcnt(4)
    v_mfma_f32_16x16x32_bf16 v[76:79], v[212:215], v[20:23], 0
    ds_read_b128 v[228:231], v4 offset:12288
    v_mfma_f32_16x16x32_bf16 v[76:79], v[216:219], v[24:27], v[76:79]
    v_cvt_pk_bf16_f32 v84, v68, v69
    ds_read_b128 v[232:235], v4 offset:13312
    v_mfma_f32_16x16x32_bf16 v[76:79], v[220:223], v[28:31], v[76:79]
    v_cvt_pk_bf16_f32 v85, v70, v71
    ds_read_b128 v[236:239], v4 offset:14336
    v_cvt_pk_bf16_f32 v86, v72, v73
    v_mfma_f32_16x16x32_bf16 v[76:79], v[224:227], v[32:35], v[76:79]
    v_cvt_pk_bf16_f32 v87, v74, v75
    ds_read_b128 v[240:243], v4 offset:15360
    v_mfma_f32_16x16x32_bf16 v[108:111], v[212:215], v[36:39], 0
    v_cvt_pk_bf16_f32 v116, v100, v101
    v_mfma_f32_16x16x32_bf16 v[108:111], v[216:219], v[40:43], v[108:111]
    v_cvt_pk_bf16_f32 v117, v102, v103
    v_mfma_f32_16x16x32_bf16 v[108:111], v[220:223], v[44:47], v[108:111]
    v_cvt_pk_bf16_f32 v118, v104, v105
    v_mfma_f32_16x16x32_bf16 v[108:111], v[224:227], v[48:51], v[108:111]
    v_cvt_pk_bf16_f32 v119, v106, v107
    v_mfma_f32_16x16x32_bf16 v[164:167], v[20:23], v[84:87], 0
    v_mfma_f32_16x16x32_bf16 v[96:99], v[16:19], v[84:87], 0
    v_mfma_f32_16x16x32_bf16 v[180:183], v[36:39], v[116:119], 0
    v_mfma_f32_16x16x32_bf16 v[128:131], v[16:19], v[116:119], 0
    s_waitcnt lgkmcnt(0)
    v_mfma_f32_16x16x32_bf16 v[80:83], v[228:231], v[20:23], 0
    ds_read_b128 v[212:215], v4 offset:16384
    v_mfma_f32_16x16x32_bf16 v[80:83], v[232:235], v[24:27], v[80:83]
    ds_read_b128 v[216:219], v4 offset:17408
    v_mfma_f32_16x16x32_bf16 v[80:83], v[236:239], v[28:31], v[80:83]
    ds_read_b128 v[220:223], v4 offset:18432
    v_mfma_f32_16x16x32_bf16 v[80:83], v[240:243], v[32:35], v[80:83]
    ds_read_b128 v[224:227], v4 offset:19456
    v_mfma_f32_16x16x32_bf16 v[112:115], v[228:231], v[36:39], 0
    v_mfma_f32_16x16x32_bf16 v[112:115], v[232:235], v[40:43], v[112:115]
    v_mfma_f32_16x16x32_bf16 v[112:115], v[236:239], v[44:47], v[112:115]
    v_mfma_f32_16x16x32_bf16 v[112:115], v[240:243], v[48:51], v[112:115]
    s_waitcnt lgkmcnt(0)
    v_mfma_f32_16x16x32_bf16 v[68:71], v[212:215], v[20:23], 0
    ds_read_b128 v[228:231], v4 offset:20480
    v_mfma_f32_16x16x32_bf16 v[68:71], v[216:219], v[24:27], v[68:71]
    v_cvt_pk_bf16_f32 v88, v76, v77
    ds_read_b128 v[232:235], v4 offset:21504
    v_mfma_f32_16x16x32_bf16 v[68:71], v[220:223], v[28:31], v[68:71]
    v_cvt_pk_bf16_f32 v89, v78, v79
    ds_read_b128 v[236:239], v4 offset:22528
    v_cvt_pk_bf16_f32 v90, v80, v81
    v_mfma_f32_16x16x32_bf16 v[68:71], v[224:227], v[32:35], v[68:71]
    v_cvt_pk_bf16_f32 v91, v82, v83
    ds_read_b128 v[240:243], v4 offset:23552
    v_mfma_f32_16x16x32_bf16 v[100:103], v[212:215], v[36:39], 0
    v_cvt_pk_bf16_f32 v120, v108, v109
    v_mfma_f32_16x16x32_bf16 v[100:103], v[216:219], v[40:43], v[100:103]
    v_cvt_pk_bf16_f32 v121, v110, v111
    v_mfma_f32_16x16x32_bf16 v[100:103], v[220:223], v[44:47], v[100:103]
    v_cvt_pk_bf16_f32 v122, v112, v113
    v_mfma_f32_16x16x32_bf16 v[100:103], v[224:227], v[48:51], v[100:103]
    v_cvt_pk_bf16_f32 v123, v114, v115
    v_mfma_f32_16x16x32_bf16 v[164:167], v[24:27], v[88:91], v[164:167]
    v_mfma_f32_16x16x32_bf16 v[96:99], v[16:19], v[88:91], v[96:99]
    v_mfma_f32_16x16x32_bf16 v[180:183], v[40:43], v[120:123], v[180:183]
    v_mfma_f32_16x16x32_bf16 v[128:131], v[16:19], v[120:123], v[128:131]
    s_waitcnt lgkmcnt(0)
    v_mfma_f32_16x16x32_bf16 v[72:75], v[228:231], v[20:23], 0
    ds_read_b128 v[212:215], v4 offset:24576
    v_mfma_f32_16x16x32_bf16 v[72:75], v[232:235], v[24:27], v[72:75]
    ds_read_b128 v[216:219], v4 offset:25600
    v_mfma_f32_16x16x32_bf16 v[72:75], v[236:239], v[28:31], v[72:75]
    ds_read_b128 v[220:223], v4 offset:26624
    v_mfma_f32_16x16x32_bf16 v[72:75], v[240:243], v[32:35], v[72:75]
    ds_read_b128 v[224:227], v4 offset:27648
    v_mfma_f32_16x16x32_bf16 v[104:107], v[228:231], v[36:39], 0
    v_mfma_f32_16x16x32_bf16 v[104:107], v[232:235], v[40:43], v[104:107]
    v_mfma_f32_16x16x32_bf16 v[104:107], v[236:239], v[44:47], v[104:107]
    v_mfma_f32_16x16x32_bf16 v[104:107], v[240:243], v[48:51], v[104:107]
    s_waitcnt lgkmcnt(0)
    v_mfma_f32_16x16x32_bf16 v[76:79], v[212:215], v[20:23], 0
    ds_read_b128 v[228:231], v4 offset:28672
    v_mfma_f32_16x16x32_bf16 v[76:79], v[216:219], v[24:27], v[76:79]
    v_cvt_pk_bf16_f32 v84, v68, v69
    ds_read_b128 v[232:235], v4 offset:29696
    v_mfma_f32_16x16x32_bf16 v[76:79], v[220:223], v[28:31], v[76:79]
    v_cvt_pk_bf16_f32 v85, v70, v71
    ds_read_b128 v[236:239], v4 offset:30720
    v_cvt_pk_bf16_f32 v86, v72, v73
    v_mfma_f32_16x16x32_bf16 v[76:79], v[224:227], v[32:35], v[76:79]
    v_cvt_pk_bf16_f32 v87, v74, v75
    ds_read_b128 v[240:243], v4 offset:31744
    v_mfma_f32_16x16x32_bf16 v[108:111], v[212:215], v[36:39], 0
    v_cvt_pk_bf16_f32 v116, v100, v101
    v_mfma_f32_16x16x32_bf16 v[108:111], v[216:219], v[40:43], v[108:111]
    v_cvt_pk_bf16_f32 v117, v102, v103
    v_mfma_f32_16x16x32_bf16 v[108:111], v[220:223], v[44:47], v[108:111]
    v_cvt_pk_bf16_f32 v118, v104, v105
    v_mfma_f32_16x16x32_bf16 v[108:111], v[224:227], v[48:51], v[108:111]
    v_cvt_pk_bf16_f32 v119, v106, v107
    v_mfma_f32_16x16x32_bf16 v[164:167], v[28:31], v[84:87], v[164:167]
    v_mfma_f32_16x16x32_bf16 v[96:99], v[16:19], v[84:87], v[96:99]
    v_mfma_f32_16x16x32_bf16 v[180:183], v[44:47], v[116:119], v[180:183]
    v_mfma_f32_16x16x32_bf16 v[128:131], v[16:19], v[116:119], v[128:131]
    s_waitcnt lgkmcnt(0)
    v_mfma_f32_16x16x32_bf16 v[80:83], v[228:231], v[20:23], 0
    ds_read_b128 v[212:215], v4 offset:32768
    v_mfma_f32_16x16x32_bf16 v[80:83], v[232:235], v[24:27], v[80:83]
    ds_read_b128 v[216:219], v4 offset:33792
    v_mfma_f32_16x16x32_bf16 v[80:83], v[236:239], v[28:31], v[80:83]
    ds_read_b128 v[220:223], v4 offset:34816
    v_mfma_f32_16x16x32_bf16 v[80:83], v[240:243], v[32:35], v[80:83]
    ds_read_b128 v[224:227], v4 offset:35840
    v_mfma_f32_16x16x32_bf16 v[112:115], v[228:231], v[36:39], 0
    v_mfma_f32_16x16x32_bf16 v[112:115], v[232:235], v[40:43], v[112:115]
    v_mfma_f32_16x16x32_bf16 v[112:115], v[236:239], v[44:47], v[112:115]
    v_mfma_f32_16x16x32_bf16 v[112:115], v[240:243], v[48:51], v[112:115]
    s_setprio 1
    s_waitcnt lgkmcnt(0)
    v_mfma_f32_16x16x32_bf16 v[244:247], v[20:23], v[212:215], 0
    ds_read_b128 v[228:231], v4 offset:36864
    v_mfma_f32_16x16x32_bf16 v[244:247], v[24:27], v[216:219], v[244:247]
    v_cvt_pk_bf16_f32 v88, v76, v77
    ds_read_b128 v[232:235], v4 offset:37888
    v_mfma_f32_16x16x32_bf16 v[244:247], v[28:31], v[220:223], v[244:247]
    v_cvt_pk_bf16_f32 v89, v78, v79
    ds_read_b128 v[236:239], v4 offset:38912
    v_cvt_pk_bf16_f32 v90, v80, v81
    v_mfma_f32_16x16x32_bf16 v[244:247], v[32:35], v[224:227], v[244:247]
    v_cvt_pk_bf16_f32 v91, v82, v83
    ds_read_b128 v[240:243], v4 offset:39936
    v_mfma_f32_16x16x32_bf16 v[248:251], v[36:39], v[212:215], 0
    v_cvt_pk_bf16_f32 v120, v108, v109
    v_mfma_f32_16x16x32_bf16 v[248:251], v[40:43], v[216:219], v[248:251]
    v_cvt_pk_bf16_f32 v121, v110, v111
    v_mfma_f32_16x16x32_bf16 v[248:251], v[44:47], v[220:223], v[248:251]
    v_cvt_pk_bf16_f32 v122, v112, v113
    v_mfma_f32_16x16x32_bf16 v[248:251], v[48:51], v[224:227], v[248:251]
    v_cvt_pk_bf16_f32 v123, v114, v115
    v_mfma_f32_16x16x32_bf16 v[164:167], v[32:35], v[88:91], v[164:167]
    v_mfma_f32_16x16x32_bf16 v[96:99], v[16:19], v[88:91], v[96:99]
    v_mfma_f32_16x16x32_bf16 v[180:183], v[48:51], v[120:123], v[180:183]
    v_mfma_f32_16x16x32_bf16 v[128:131], v[16:19], v[120:123], v[128:131]
    s_waitcnt lgkmcnt(0)
    v_mfma_f32_16x16x32_bf16 v[252:255], v[20:23], v[228:231], 0
    ds_read_b128 v[212:215], v4 offset:40960
    v_mfma_f32_16x16x32_bf16 v[252:255], v[24:27], v[232:235], v[252:255]
    ds_read_b128 v[216:219], v4 offset:41984
    v_mfma_f32_16x16x32_bf16 v[252:255], v[28:31], v[236:239], v[252:255]
    ds_read_b128 v[220:223], v4 offset:43008
    v_mul_f32 v164, v164, v168
    v_mfma_f32_16x16x32_bf16 v[252:255], v[32:35], v[240:243], v[252:255]
    v_mul_f32 v180, v180, v184
    ds_read_b128 v[224:227], v4 offset:44032
    v_mul_f32 v165, v165, v169
    v_cvt_pk_bf16_f32 v70, v244, v245
    v_mul_f32 v181, v181, v185
    v_cvt_pk_bf16_f32 v71, v246, v247
    v_mul_f32 v166, v166, v170
    v_mfma_f32_16x16x32_bf16 v[244:247], v[36:39], v[228:231], 0
    v_mul_f32 v182, v182, v186
    v_mfma_f32_16x16x32_bf16 v[244:247], v[40:43], v[232:235], v[244:247]
    v_mul_f32 v167, v167, v171
    v_mfma_f32_16x16x32_bf16 v[244:247], v[44:47], v[236:239], v[244:247]
    v_mul_f32 v183, v183, v187
    v_mfma_f32_16x16x32_bf16 v[244:247], v[48:51], v[240:243], v[244:247]
    v_fma_f32 v164, -v96, v172, v164
    v_cvt_pk_bf16_f32 v102, v248, v249
    v_fma_f32 v180, -v128, v188, v180
    v_cvt_pk_bf16_f32 v103, v250, v251
    v_fma_f32 v165, -v96, v173, v165
    v_fma_f32 v181, -v128, v189, v181
    s_waitcnt lgkmcnt(0)
    v_fma_f32 v166, -v96, v174, v166
    v_mfma_f32_16x16x32_bf16 v[248:251], v[20:23], v[212:215], 0
    v_fma_f32 v182, -v128, v190, v182
    ds_read_b128 v[228:231], v4 offset:45056
    v_fma_f32 v167, -v96, v175, v167
    v_mfma_f32_16x16x32_bf16 v[248:251], v[24:27], v[216:219], v[248:251]
    v_fma_f32 v183, -v128, v191, v183
    ds_read_b128 v[232:235], v4 offset:46080
    v_mul_f32 v72, s76, v92
    v_mfma_f32_16x16x32_bf16 v[248:251], v[28:31], v[220:223], v[248:251]
    v_mul_f32 v104, s76, v124
    ds_read_b128 v[236:239], v4 offset:47104
    v_max3_f32 v68, v164, v165, v166
    v_mfma_f32_16x16x32_bf16 v[248:251], v[32:35], v[224:227], v[248:251]
    v_max3_f32 v100, v180, v181, v182
    ds_read_b128 v[240:243], v4 offset:48128
    v_max_f32 v68, v68, v167
    v_cvt_pk_bf16_f32 v74, v252, v253
    v_max_f32 v100, v100, v183
    v_cvt_pk_bf16_f32 v75, v254, v255
    v_mov_b32 v69, v68
    v_mfma_f32_16x16x32_bf16 v[252:255], v[36:39], v[212:215], 0
    v_mov_b32 v101, v100
    v_mfma_f32_16x16x32_bf16 v[252:255], v[40:43], v[216:219], v[252:255]
    v_permlane16_swap_b32 v68, v69
    v_mfma_f32_16x16x32_bf16 v[252:255], v[44:47], v[220:223], v[252:255]
    v_permlane16_swap_b32 v100, v101
    v_mfma_f32_16x16x32_bf16 v[252:255], v[48:51], v[224:227], v[252:255]
    v_max_f32 v68, v68, v69
    v_cvt_pk_bf16_f32 v106, v244, v245
    v_max_f32 v100, v100, v101
    v_cvt_pk_bf16_f32 v107, v246, v247
    v_mul_f32 v73, v68, v72
    v_mul_f32 v105, v100, v104
    s_waitcnt lgkmcnt(0)
    v_fma_f32 v164, v164, v72, -v73
    v_mfma_f32_16x16x32_bf16 v[244:247], v[20:23], v[228:231], 0
    v_fma_f32 v180, v180, v104, -v105
    ds_read_b128 v[212:215], v4 offset:49152
    v_fma_f32 v165, v165, v72, -v73
    v_mfma_f32_16x16x32_bf16 v[244:247], v[24:27], v[232:235], v[244:247]
    v_fma_f32 v181, v181, v104, -v105
    ds_read_b128 v[216:219], v4 offset:50176
    v_fma_f32 v166, v166, v72, -v73
    v_mfma_f32_16x16x32_bf16 v[244:247], v[28:31], v[236:239], v[244:247]
    v_fma_f32 v182, v182, v104, -v105
    ds_read_b128 v[220:223], v4 offset:51200
    v_fma_f32 v167, v167, v72, -v73
    v_mfma_f32_16x16x32_bf16 v[244:247], v[32:35], v[240:243], v[244:247]
    v_fma_f32 v183, v183, v104, -v105
    ds_read_b128 v[224:227], v4 offset:52224
    v_exp_f32 v164, v164
    v_cvt_pk_bf16_f32 v78, v248, v249
    v_exp_f32 v180, v180
    v_cvt_pk_bf16_f32 v79, v250, v251
    v_exp_f32 v165, v165
    v_mfma_f32_16x16x32_bf16 v[248:251], v[36:39], v[228:231], 0
    v_exp_f32 v181, v181
    v_mfma_f32_16x16x32_bf16 v[248:251], v[40:43], v[232:235], v[248:251]
    v_exp_f32 v166, v166
    v_mfma_f32_16x16x32_bf16 v[248:251], v[44:47], v[236:239], v[248:251]
    v_exp_f32 v182, v182
    v_mfma_f32_16x16x32_bf16 v[248:251], v[48:51], v[240:243], v[248:251]
    v_exp_f32 v167, v167
    v_cvt_pk_bf16_f32 v110, v252, v253
    v_exp_f32 v183, v183
    v_cvt_pk_bf16_f32 v111, v254, v255
    v_add_f32 v68, v164, v166
    v_add_f32 v100, v180, v182
    s_waitcnt lgkmcnt(0)
    v_add_f32 v69, v165, v167
    v_mfma_f32_16x16x32_bf16 v[252:255], v[20:23], v[212:215], 0
    v_add_f32 v101, v181, v183
    ds_read_b128 v[228:231], v4 offset:53248
    v_mul_f32 v164, v164, v168
    v_mfma_f32_16x16x32_bf16 v[252:255], v[24:27], v[216:219], v[252:255]
    v_mul_f32 v180, v180, v184
    ds_read_b128 v[232:235], v4 offset:54272
    v_mul_f32 v165, v165, v169
    v_mfma_f32_16x16x32_bf16 v[252:255], v[28:31], v[220:223], v[252:255]
    v_mul_f32 v181, v181, v185
    ds_read_b128 v[236:239], v4 offset:55296
    v_add_f32 v68, v68, v69
    v_mfma_f32_16x16x32_bf16 v[252:255], v[32:35], v[224:227], v[252:255]
    v_add_f32 v100, v100, v101
    ds_read_b128 v[240:243], v4 offset:56320
    v_mul_f32 v166, v166, v170
    v_cvt_pk_bf16_f32 v82, v244, v245
    v_mul_f32 v182, v182, v186
    v_cvt_pk_bf16_f32 v83, v246, v247
    v_mul_f32 v167, v167, v171
    v_mfma_f32_16x16x32_bf16 v[244:247], v[36:39], v[212:215], 0
    v_mul_f32 v183, v183, v187
    v_mfma_f32_16x16x32_bf16 v[244:247], v[40:43], v[216:219], v[244:247]
    v_mov_b32 v69, v68
    v_mfma_f32_16x16x32_bf16 v[244:247], v[44:47], v[220:223], v[244:247]
    v_mov_b32 v101, v100
    v_mfma_f32_16x16x32_bf16 v[244:247], v[48:51], v[224:227], v[244:247]
    v_permlane16_swap_b32 v68, v69
    v_cvt_pk_bf16_f32 v114, v248, v249
    v_permlane16_swap_b32 v100, v101
    v_cvt_pk_bf16_f32 v115, v250, v251
    v_add_f32 v68, v68, v69
    v_add_f32 v100, v100, v101
    s_waitcnt lgkmcnt(0)
    v_rcp_f32 v68, v68
    v_mfma_f32_16x16x32_bf16 v[248:251], v[20:23], v[228:231], 0
    v_rcp_f32 v100, v100
    ds_read_b128 v[212:215], v4 offset:57344
    v_mul_f32 v164, v164, v68
    v_mfma_f32_16x16x32_bf16 v[248:251], v[24:27], v[232:235], v[248:251]
    v_mul_f32 v180, v180, v100
    ds_read_b128 v[216:219], v4 offset:58368
    v_mul_f32 v165, v165, v68
    v_mfma_f32_16x16x32_bf16 v[248:251], v[28:31], v[236:239], v[248:251]
    v_mul_f32 v181, v181, v100
    ds_read_b128 v[220:223], v4 offset:59392
    v_mul_f32 v166, v166, v68
    v_mfma_f32_16x16x32_bf16 v[248:251], v[32:35], v[240:243], v[248:251]
    v_mul_f32 v182, v182, v100
    ds_read_b128 v[224:227], v4 offset:60416
    v_mul_f32 v167, v167, v68
    v_cvt_pk_bf16_f32 v86, v252, v253
    v_mul_f32 v183, v183, v100
    v_cvt_pk_bf16_f32 v87, v254, v255
    v_cvt_pk_bf16_f32 v68, v164, v165
    v_mfma_f32_16x16x32_bf16 v[252:255], v[36:39], v[228:231], 0
    v_cvt_pk_bf16_f32 v100, v180, v181
    v_mfma_f32_16x16x32_bf16 v[252:255], v[40:43], v[232:235], v[252:255]
    v_cvt_pk_bf16_f32 v69, v166, v167
    v_mfma_f32_16x16x32_bf16 v[252:255], v[44:47], v[236:239], v[252:255]
    v_cvt_pk_bf16_f32 v101, v182, v183
    v_mfma_f32_16x16x32_bf16 v[252:255], v[48:51], v[240:243], v[252:255]
    v_cndmask_b32 v178, 0, v68, s[66:67]
    v_cvt_pk_bf16_f32 v118, v244, v245
    v_cndmask_b32 v194, 0, v100, s[66:67]
    v_cvt_pk_bf16_f32 v119, v246, v247
    v_cndmask_b32 v179, 0, v69, s[66:67]
    v_cndmask_b32 v195, 0, v101, s[66:67]
    s_waitcnt lgkmcnt(0)
    v_mfma_f32_16x16x32_bf16 v[244:247], v[20:23], v[212:215], 0
    ds_read_b128 v[228:231], v4 offset:61440
    ds_read_b64_tr_b16 v[68:69], v3 offset:0
    v_mfma_f32_16x16x32_bf16 v[244:247], v[24:27], v[216:219], v[244:247]
    ds_read_b128 v[232:235], v4 offset:62464
    ds_read_b64_tr_b16 v[100:101], v3 offset:128
    v_mfma_f32_16x16x32_bf16 v[244:247], v[28:31], v[220:223], v[244:247]
    ds_read_b128 v[236:239], v4 offset:63488
    ds_read_b64_tr_b16 v[72:73], v3 offset:320
    v_mfma_f32_16x16x32_bf16 v[244:247], v[32:35], v[224:227], v[244:247]
    ds_read_b128 v[240:243], v4 offset:64512
    ds_read_b64_tr_b16 v[104:105], v3 offset:448
    v_cvt_pk_bf16_f32 v90, v248, v249
    v_cvt_pk_bf16_f32 v91, v250, v251
    ds_read_b64_tr_b16 v[76:77], v3 offset:2560
    v_mfma_f32_16x16x32_bf16 v[248:251], v[36:39], v[212:215], 0
    v_mfma_f32_16x16x32_bf16 v[248:251], v[40:43], v[216:219], v[248:251]
    v_mfma_f32_16x16x32_bf16 v[248:251], v[44:47], v[220:223], v[248:251]
    ds_read_b64_tr_b16 v[108:109], v3 offset:2688
    v_mfma_f32_16x16x32_bf16 v[248:251], v[48:51], v[224:227], v[248:251]
    v_cvt_pk_bf16_f32 v122, v252, v253
    ds_read_b64_tr_b16 v[80:81], v3 offset:2880
    v_cvt_pk_bf16_f32 v123, v254, v255
    s_waitcnt lgkmcnt(4)
    ds_read_b64_tr_b16 v[112:113], v3 offset:3008
    v_mfma_f32_16x16x32_bf16 v[252:255], v[20:23], v[228:231], 0
    v_add_u32 v4, 65536, v4
    ds_read_b64_tr_b16 v[84:85], v3 offset:5120
    v_mfma_f32_16x16x32_bf16 v[252:255], v[24:27], v[232:235], v[252:255]
    ds_read_b128 v[212:215], v4 offset:0
    ds_read_b64_tr_b16 v[116:117], v3 offset:5248
    v_mfma_f32_16x16x32_bf16 v[252:255], v[28:31], v[236:239], v[252:255]
    ds_read_b128 v[216:219], v4 offset:1024
    v_mfma_f32_16x16x32_bf16 v[252:255], v[32:35], v[240:243], v[252:255]
    ds_read_b64_tr_b16 v[88:89], v3 offset:5440
    ds_read_b128 v[220:223], v4 offset:2048
    v_cvt_pk_bf16_f32 v94, v244, v245
    ds_read_b64_tr_b16 v[120:121], v3 offset:5568
    ds_read_b128 v[224:227], v4 offset:3072
    v_cvt_pk_bf16_f32 v95, v246, v247
    ds_read_b64_tr_b16 v[92:93], v3 offset:7680
    v_mfma_f32_16x16x32_bf16 v[244:247], v[36:39], v[228:231], 0
    v_mfma_f32_16x16x32_bf16 v[244:247], v[40:43], v[232:235], v[244:247]
    ds_read_b64_tr_b16 v[124:125], v3 offset:7808
    v_mfma_f32_16x16x32_bf16 v[244:247], v[44:47], v[236:239], v[244:247]
    v_mfma_f32_16x16x32_bf16 v[244:247], v[48:51], v[240:243], v[244:247]
    ds_read_b64_tr_b16 v[96:97], v3 offset:8000
    v_cvt_pk_bf16_f32 v126, v248, v249
    v_cvt_pk_bf16_f32 v127, v250, v251
    ds_read_b64_tr_b16 v[128:129], v3 offset:8128
    v_cvt_pk_bf16_f32 v98, v252, v253
    v_cvt_pk_bf16_f32 v99, v254, v255
    s_nop 1
    v_cvt_pk_bf16_f32 v130, v244, v245
    v_cvt_pk_bf16_f32 v131, v246, v247
    v_mfma_f32_16x16x16_bf16 v[168:171], v[178:179], v[176:177], 0
    v_mfma_f32_16x16x16_bf16 v[184:187], v[194:195], v[192:193], 0
    v_mfma_f32_16x16x32_bf16 v[244:247], v[68:71], v[176:179], 0
    v_mfma_f32_16x16x32_bf16 v[248:251], v[100:103], v[192:195], 0
    v_mfma_f32_16x16x32_bf16 v[252:255], v[72:75], v[176:179], 0
    s_waitcnt lgkmcnt(15)
    v_mfma_f32_16x16x32_bf16 v[228:231], v[104:107], v[192:195], 0
    v_mfma_f32_16x16x32_bf16 v[232:235], v[76:79], v[176:179], 0
    s_nop 2
    v_cvt_pk_bf16_f32 v20, v244, v245
    v_cvt_pk_bf16_f32 v21, v246, v247
    s_waitcnt lgkmcnt(14)
    v_mfma_f32_16x16x32_bf16 v[236:239], v[108:111], v[192:195], 0
    v_cvt_pk_bf16_f32 v36, v248, v249
    v_cvt_pk_bf16_f32 v37, v250, v251
    s_waitcnt lgkmcnt(13)
    v_mfma_f32_16x16x32_bf16 v[240:243], v[80:83], v[176:179], 0
    v_cvt_pk_bf16_f32 v22, v252, v253
    v_cvt_pk_bf16_f32 v23, v254, v255
    s_waitcnt lgkmcnt(12)
    v_mfma_f32_16x16x32_bf16 v[244:247], v[112:115], v[192:195], 0
    v_cvt_pk_bf16_f32 v38, v228, v229
    v_cvt_pk_bf16_f32 v39, v230, v231
    s_waitcnt lgkmcnt(11)
    v_mfma_f32_16x16x32_bf16 v[248:251], v[84:87], v[176:179], 0
    v_cvt_pk_bf16_f32 v24, v232, v233
    v_cvt_pk_bf16_f32 v25, v234, v235
    s_waitcnt lgkmcnt(9)
    v_mfma_f32_16x16x32_bf16 v[252:255], v[116:119], v[192:195], 0
    v_cvt_pk_bf16_f32 v40, v236, v237
    v_cvt_pk_bf16_f32 v41, v238, v239
    s_waitcnt lgkmcnt(7)
    v_mfma_f32_16x16x32_bf16 v[228:231], v[88:91], v[176:179], 0
    v_cvt_pk_bf16_f32 v26, v240, v241
    v_cvt_pk_bf16_f32 v27, v242, v243
    s_waitcnt lgkmcnt(5)
    v_mfma_f32_16x16x32_bf16 v[232:235], v[120:123], v[192:195], 0
    v_cvt_pk_bf16_f32 v42, v244, v245
    v_cvt_pk_bf16_f32 v43, v246, v247
    s_waitcnt lgkmcnt(3)
    v_mfma_f32_16x16x32_bf16 v[236:239], v[92:95], v[176:179], 0
    v_cvt_pk_bf16_f32 v28, v248, v249
    v_cvt_pk_bf16_f32 v29, v250, v251
    s_waitcnt lgkmcnt(2)
    v_mfma_f32_16x16x32_bf16 v[240:243], v[124:127], v[192:195], 0
    v_cvt_pk_bf16_f32 v44, v252, v253
    v_cvt_pk_bf16_f32 v45, v254, v255
    s_waitcnt lgkmcnt(1)
    v_mfma_f32_16x16x32_bf16 v[244:247], v[96:99], v[176:179], 0
    v_cvt_pk_bf16_f32 v30, v228, v229
    v_cvt_pk_bf16_f32 v31, v230, v231
    s_waitcnt lgkmcnt(0)
    v_mfma_f32_16x16x32_bf16 v[248:251], v[128:131], v[192:195], 0
    v_cvt_pk_bf16_f32 v46, v232, v233
    v_cvt_pk_bf16_f32 v47, v234, v235
    v_cvt_pk_bf16_f32 v32, v236, v237
    v_cvt_pk_bf16_f32 v33, v238, v239
    v_cvt_pk_bf16_f32 v48, v240, v241
    v_cvt_pk_bf16_f32 v49, v242, v243
    v_cvt_pk_bf16_f32 v34, v244, v245
    v_cvt_pk_bf16_f32 v35, v246, v247
    v_cvt_pk_bf16_f32 v50, v248, v249
    v_cvt_pk_bf16_f32 v51, v250, v251
    v_cvt_pk_bf16_f32 v168, v168, v169
    v_cvt_pk_bf16_f32 v169, v170, v171
    v_cvt_pk_bf16_f32 v184, v184, v185
    v_cvt_pk_bf16_f32 v185, v186, v187
    v_mfma_f32_16x16x32_bf16 v[164:167], v[20:23], v[20:23], 0
    v_mfma_f32_16x16x32_bf16 v[164:167], v[24:27], v[24:27], v[164:167]
    v_mfma_f32_16x16x32_bf16 v[164:167], v[28:31], v[28:31], v[164:167]
    v_mfma_f32_16x16x32_bf16 v[164:167], v[32:35], v[32:35], v[164:167]
    v_mfma_f32_16x16x32_bf16 v[172:175], v[212:215], v[20:23], 0
    v_mfma_f32_16x16x32_bf16 v[172:175], v[216:219], v[24:27], v[172:175]
    v_mfma_f32_16x16x32_bf16 v[172:175], v[220:223], v[28:31], v[172:175]
    v_mfma_f32_16x16x32_bf16 v[172:175], v[224:227], v[32:35], v[172:175]
    v_mfma_f32_16x16x32_bf16 v[180:183], v[36:39], v[36:39], 0
    v_mfma_f32_16x16x32_bf16 v[180:183], v[40:43], v[40:43], v[180:183]
    v_mfma_f32_16x16x32_bf16 v[180:183], v[44:47], v[44:47], v[180:183]
    v_mfma_f32_16x16x32_bf16 v[180:183], v[48:51], v[48:51], v[180:183]
    v_mfma_f32_16x16x32_bf16 v[188:191], v[212:215], v[36:39], 0
    v_mfma_f32_16x16x32_bf16 v[188:191], v[216:219], v[40:43], v[188:191]
    v_mfma_f32_16x16x32_bf16 v[188:191], v[220:223], v[44:47], v[188:191]
    v_mfma_f32_16x16x32_bf16 v[188:191], v[224:227], v[48:51], v[188:191]
    v_cndmask_b32 v164, v164, v165, s[60:61]
    s_nop 2
    v_cndmask_b32 v180, v180, v181, s[60:61]
    v_mul_f32 v172, s74, v172
    s_nop 1
    v_mul_f32 v188, s74, v188
    v_cndmask_b32 v164, v164, v166, s[62:63]
    v_cndmask_b32 v180, v180, v182, s[62:63]
    v_mul_f32 v174, v172, v172
    v_mul_f32 v190, v188, v188
    v_cndmask_b32 v164, v164, v167, s[64:65]
    v_cndmask_b32 v180, v180, v183, s[64:65]
    v_fma_f32 v164, v164, s74, -v174
    v_fma_f32 v180, v180, s74, -v190
    v_fma_f32 v173, -v172, v10, v173
    v_fma_f32 v189, -v188, v10, v189
    v_max_f32 v164, 0, v164
    v_max_f32 v180, 0, v180
    v_add_f32 v164, s75, v164
    v_add_f32 v180, s75, v180
    v_rsq_f32 v164, v164
    v_rsq_f32 v180, v180
    v_mul_f32 v173, s77, v173
    v_mul_f32 v189, s77, v189
    v_mul_f32 v164, v164, v173
    v_mul_f32 v180, v180, v189
    ds_write_b32 v5, v164 offset:0
    ds_write_b32 v5, v180 offset:256
    ds_read_b128 v[164:167], v7 offset:0
    ds_read_b128 v[180:183], v7 offset:256
    ds_read_b128 v[172:175], v8 offset:0
    ds_read_b128 v[188:191], v8 offset:256
    s_waitcnt lgkmcnt(3)
    v_max3_f32 v170, v164, v165, v166
    s_waitcnt lgkmcnt(2)
    v_max3_f32 v186, v180, v181, v182
    s_waitcnt lgkmcnt(1)
    v_max3_f32 v171, v172, v173, v174
    s_waitcnt lgkmcnt(0)
    v_max3_f32 v187, v188, v189, v190
    v_max3_f32 v170, v170, v167, v175
    v_max3_f32 v186, v186, v183, v191
    v_max_f32 v170, v170, v171
    v_max_f32 v186, v186, v187
    v_pk_add_f32 v[164:165], v[164:165], v[170:171] op_sel_hi:[1,0] neg_lo:[0,1] neg_hi:[0,1]
    v_pk_add_f32 v[180:181], v[180:181], v[186:187] op_sel_hi:[1,0] neg_lo:[0,1] neg_hi:[0,1]
    v_pk_add_f32 v[166:167], v[166:167], v[170:171] op_sel_hi:[1,0] neg_lo:[0,1] neg_hi:[0,1]
    v_pk_add_f32 v[182:183], v[182:183], v[186:187] op_sel_hi:[1,0] neg_lo:[0,1] neg_hi:[0,1]
    v_exp_f32 v164, v164
    v_exp_f32 v180, v180
    v_exp_f32 v165, v165
    v_exp_f32 v181, v181
    v_exp_f32 v166, v166
    v_exp_f32 v182, v182
    v_exp_f32 v167, v167
    v_exp_f32 v183, v183
    v_pk_add_f32 v[170:171], v[164:165], v[166:167]
    v_pk_add_f32 v[186:187], v[180:181], v[182:183]
    v_add_f32 v170, v170, v171
    v_add_f32 v186, v186, v187
    v_mov_b32 v171, v170
    v_mov_b32 v187, v186
    s_nop 0
    v_permlane16_swap_b32 v170, v171
    v_permlane16_swap_b32 v186, v187
    v_add_f32 v170, v170, v171
    v_add_f32 v186, v186, v187
    v_rcp_f32 v170, v170
    v_rcp_f32 v186, v186
    v_pk_mul_f32 v[164:165], v[164:165], v[170:171] op_sel_hi:[1,0]
    v_pk_mul_f32 v[180:181], v[180:181], v[186:187] op_sel_hi:[1,0]
    v_pk_mul_f32 v[166:167], v[166:167], v[170:171] op_sel_hi:[1,0]
    v_pk_mul_f32 v[182:183], v[182:183], v[186:187] op_sel_hi:[1,0]
    v_cvt_pk_bf16_f32 v170, v164, v165
    v_cvt_pk_bf16_f32 v186, v180, v181
    v_cvt_pk_bf16_f32 v171, v166, v167
    v_cvt_pk_bf16_f32 v187, v182, v183
    v_cndmask_b32 v172, 0, v170, s[68:69]
    v_cndmask_b32 v188, 0, v186, s[70:71]
    v_cndmask_b32 v173, 0, v171, s[68:69]
    v_cndmask_b32 v189, 0, v187, s[70:71]
    s_nop 0
    v_mfma_f32_16x16x16_bf16 v[164:167], v[168:169], v[172:173], 0
    v_mfma_f32_16x16x16_bf16 v[180:183], v[184:185], v[188:189], 0
    s_nop 6
    v_cvt_pk_bf16_f32 v174, v164, v165
    v_cvt_pk_bf16_f32 v175, v166, v167
    v_cvt_pk_bf16_f32 v190, v180, v181
    v_cvt_pk_bf16_f32 v191, v182, v183
    v_mfma_f32_16x16x32_bf16 v[212:215], v[68:71], v[172:175], 0
    v_mfma_f32_16x16x32_bf16 v[216:219], v[72:75], v[172:175], 0
    v_mfma_f32_16x16x32_bf16 v[220:223], v[76:79], v[172:175], 0
    v_mfma_f32_16x16x32_bf16 v[224:227], v[80:83], v[172:175], 0
    v_mfma_f32_16x16x32_bf16 v[228:231], v[84:87], v[172:175], 0
    v_mfma_f32_16x16x32_bf16 v[232:235], v[88:91], v[172:175], 0
    v_mfma_f32_16x16x32_bf16 v[236:239], v[92:95], v[172:175], 0
    v_mfma_f32_16x16x32_bf16 v[240:243], v[96:99], v[172:175], 0
    v_mfma_f32_16x16x32_bf16 v[212:215], v[100:103], v[188:191], v[212:215]
    v_mfma_f32_16x16x32_bf16 v[216:219], v[104:107], v[188:191], v[216:219]
    v_mfma_f32_16x16x32_bf16 v[220:223], v[108:111], v[188:191], v[220:223]
    v_mfma_f32_16x16x32_bf16 v[224:227], v[112:115], v[188:191], v[224:227]
    v_mfma_f32_16x16x32_bf16 v[228:231], v[116:119], v[188:191], v[228:231]
    v_mfma_f32_16x16x32_bf16 v[232:235], v[120:123], v[188:191], v[232:235]
    v_mfma_f32_16x16x32_bf16 v[236:239], v[124:127], v[188:191], v[236:239]
    v_mfma_f32_16x16x32_bf16 v[240:243], v[128:131], v[188:191], v[240:243]
    s_nop 0
    v_cvt_pk_bf16_f32 v20, v212, v213
    v_cvt_pk_bf16_f32 v21, v214, v215
    v_cvt_pk_bf16_f32 v22, v216, v217
    v_cvt_pk_bf16_f32 v23, v218, v219
    buffer_store_dwordx4 v[20:23], v9, s[28:31], 0 offen offset:0
    v_cvt_pk_bf16_f32 v24, v220, v221
    v_cvt_pk_bf16_f32 v25, v222, v223
    v_cvt_pk_bf16_f32 v26, v224, v225
    v_cvt_pk_bf16_f32 v27, v226, v227
    buffer_store_dwordx4 v[24:27], v9, s[28:31], 0 offen offset:64
    v_cvt_pk_bf16_f32 v28, v228, v229
    v_cvt_pk_bf16_f32 v29, v230, v231
    v_cvt_pk_bf16_f32 v30, v232, v233
    v_cvt_pk_bf16_f32 v31, v234, v235
    buffer_store_dwordx4 v[28:31], v9, s[28:31], 0 offen offset:128
    v_cvt_pk_bf16_f32 v32, v236, v237
    v_cvt_pk_bf16_f32 v33, v238, v239
    v_cvt_pk_bf16_f32 v34, v240, v241
    v_cvt_pk_bf16_f32 v35, v242, v243
    buffer_store_dwordx4 v[32:35], v9, s[28:31], 0 offen offset:192
    s_nop 1
L_tf_fin:
L_end:
    s_endpgm
L_code_end:
.section .rodata,"a"
.p2align 6
.amdhsa_kernel gather_scatter__hybrid_graph_tf_nagphormer__graph_kernel
.amdhsa_next_free_vgpr 256
.amdhsa_next_free_sgpr 102
.amdhsa_accum_offset 256
.amdhsa_group_segment_fixed_size 0
.amdhsa_kernarg_size 96
.amdhsa_user_sgpr_count 2
.amdhsa_user_sgpr_kernarg_segment_ptr 1
.amdhsa_system_sgpr_workgroup_id_x 1
.amdhsa_float_denorm_mode_32 3
.end_amdhsa_kernel
```
